```python
import torch

def _softmax(x, axis=-1):
    return torch.softmax(x, dim=axis)
def _gelu(x):
    return torch.nn.functional.gelu(x, approximate="tanh")
def _silu(x):
    return torch.nn.functional.silu(x)
def _sigmoid(x):
    return torch.sigmoid(x)
def _layernorm(x, axis=-1, eps=1e-5):
    m = x.mean(dim=axis, keepdim=True)
    v = x.var(dim=axis, keepdim=True, unbiased=False)
    return (x - m) / torch.sqrt(v + eps)
def _scatter_add(tgt, idx, src, axis=0):
    return tgt.clone().index_add_(axis, idx, src)
def _segment_sum(src, seg, n):
    out = torch.zeros((n,) + src.shape[1:], dtype=src.dtype)
    return out.index_add_(0, seg, src)
def _pad(x, pw):
    flat = tuple(v for pair in reversed(pw) for v in pair)
    return torch.nn.functional.pad(x, flat)

kernel_name = 'sequential_preLN__ssm_conv_h3__dense_activation_silu__prompt'

def setup_inputs():

    _w = (lambda a: (lambda t: t.to(torch.bfloat16) if t.is_floating_point() else t)(torch.as_tensor(a)))
    def _A_setup():
        B, S, D = 1, 2048, 1024
        ks = 4
        return {
            "q": _w((lambda *s: torch.randn(*s, dtype=torch.bfloat16) * 0.05)(B, S, D)),
            "k": _w((lambda *s: torch.randn(*s, dtype=torch.bfloat16) * 0.2)(B, S, D)),
            "v": _w((lambda *s: torch.randn(*s, dtype=torch.bfloat16) * 0.2)(B, S, D)),
            "shift_k": _w((lambda *s: torch.randn(*s, dtype=torch.bfloat16) * 0.2)(D, ks) * 0.5),
            "ssm_k": _w((lambda *s: torch.randn(*s, dtype=torch.bfloat16) * 0.4)(D, S) * (1.0 / S ** 0.5)),
            "ssm_D": _w((lambda *s: torch.randn(*s, dtype=torch.bfloat16) * 0.2)(D)),
        }
    _A_in = _A_setup()

    def _B_setup():
        B, S, D, F = 1, 2048, 1024, 3584
        return {
            "x": _w((lambda *s: torch.randn(*s, dtype=torch.bfloat16) * 0.05)(B, S, D)),
            "w1": _w((lambda *s: torch.randn(*s, dtype=torch.bfloat16) * 0.8)(D, F) * (D ** -0.5)),
            "w2": _w((lambda *s: torch.randn(*s, dtype=torch.bfloat16) * 0.1)(F, D) * (F ** -0.5)),
        }
    _B_in = _B_setup()

    return {
        "A_q": _A_in["q"],
        "A_k": _A_in["k"],
        "A_v": _A_in["v"],
        "A_shift_k": _A_in["shift_k"],
        "A_ssm_k": _A_in["ssm_k"],
        "A_ssm_D": _A_in["ssm_D"],
        "B_x": _B_in["x"],
        "B_w1": _B_in["w1"],
        "B_w2": _B_in["w2"],
    }

def reference(A_q, A_k, A_v, A_shift_k, A_ssm_k, A_ssm_D, B_x, B_w1, B_w2):
    def _A_ref(q, k, v, shift_k, ssm_k, ssm_D):
        B, S, D = q.shape
        ks = shift_k.shape[-1]
        k_pad = _pad(k, ((0, 0), (ks - 1, 0), (0, 0)))
        k_shift = torch.zeros_like(k)
        for t in range(ks):
            k_shift = k_shift + k_pad[:, t:t + S, :] * shift_k[:, ks - 1 - t][None, None, :]
        kv = k_shift * v
        L = 2 * S
        kv_pad = _pad(kv, ((0, 0), (0, S), (0, 0)))
        kf_pad = _pad(ssm_k, ((0, 0), (0, S)))
        kv_f = (lambda x, axes=(-2,-1): torch.fft.rfft2(x.float(), dim=axes))(kv_pad[:, None, :, :], axes=(1, 2))
        kf_f = (lambda x, axes=(-2,-1): torch.fft.rfft2(x.float(), dim=axes))(kf_pad[:, None, :], axes=(1, 2))
        kf_f = (lambda x, *d: x.permute(*d))(kf_f, 1, 2, 0)
        y_f = kv_f * kf_f[None, :, :, :]
        y = (lambda x, s, axes=(-2,-1): torch.fft.irfft2(x, s=s, dim=axes).to(torch.bfloat16))(y_f, (1, L), axes=(1, 2))[:, 0, :S, :]
        y = y + kv * ssm_D[None, None, :]
        return q * y

    def _B_ref(x, w1, w2):
        h = torch.einsum("bsd,df->bsf", x, w1)
        h = _silu(h)
        out = torch.einsum("bsf,fd->bsd", h, w2)
        return out

    x = A_q
    h = x + _A_ref(_layernorm(x, axis=-1), A_k, A_v, A_shift_k, A_ssm_k, A_ssm_D)
    h2 = h + _B_ref(_layernorm(h, axis=-1), B_w1, B_w2)
    return h2
```

```asm
; @launch grid=(256,1,1) block=(512,1,1) lds=162880
.amdgcn_target "amdgcn-amd-amdhsa--gfx950"
.text
.globl sequential_preLN__ssm_conv_h3__dense_activation_silu__prompt_kernel
.p2align 8
.type sequential_preLN__ssm_conv_h3__dense_activation_silu__prompt_kernel,@function
sequential_preLN__ssm_conv_h3__dense_activation_silu__prompt_kernel:
  s_cmp_ge_u32 s2, 256
  s_cbranch_scc1 MK_END
  s_load_dwordx8 s[24:31], s[0:1], 0
  s_load_dwordx4 s[8:11], s[0:1], 32
  s_load_dwordx4 s[4:7], s[0:1], 56
  s_load_dwordx4 s[64:67], s[0:1], 72
  s_load_dwordx2 s[12:13], s[0:1], 88
  s_and_b32 s14, s2, 7
  s_lshl_b32 s14, s14, 5
  s_lshr_b32 s15, s2, 3
  s_add_u32 s14, s14, s15
  s_lshr_b32 s15, s14, 6
  s_and_b32 s14, s14, 63
  v_lshrrev_b32 v2, 6, v0
  v_and_b32 v1, 63, v0
  s_nop 0
  v_readfirstlane_b32 s16, v2
  s_nop 0
  s_and_b32 s17, s16, 3
  s_lshl_b32 s19, s14, 4
  s_lshl_b32 s20, s17, 2
  s_add_u32 s19, s19, s20
  s_add_u32 s19, s19, s15
  s_cmp_lt_u32 s16, 4
  s_cbranch_scc1 MK_C
  v_lshlrev_b32 v6, 4, v1
  v_add_u32_e64 v4, -8, v6
  v_add_u32 v5, 0xffffffe0, v6
  v_cmp_eq_u32 vcc, 2, v1
  s_nop 0
  v_mov_b32 v7, 4096
  s_nop 0
  v_cndmask_b32 v5, v5, v7, vcc
  v_add_u32 v7, -8, v5
  v_mov_b32 v8, 0
  v_mov_b32 v9, 0
  v_mov_b32 v10, 0
  v_mov_b32_e64 v11, 0
  v_mov_b32 v219, 162816
  v_mov_b32_e64 v221, 1
  ds_write_b128 v219, v[8:11] offset:0
  ds_write_b128 v219, v[8:11] offset:16
  ds_write_b128 v219, v[8:11] offset:32
  ds_write_b128 v219, v[8:11] offset:48
  s_waitcnt lgkmcnt(0)
  s_lshl_b32 s20, s19, 12
  s_add_u32 s8, s8, s20
  s_addc_u32 s9, s9, 0
  s_mov_b32 s24, s8
  s_and_b32 s25, s9, 0xffff
  s_mov_b32 s26, 0x1000
  s_mov_b32 s27, 0x00020000
  s_mov_b32 s44, s12
  s_and_b32 s45, s13, 0xffff
  s_mov_b32 s46, 0x4000000
  s_mov_b32 s47, 0x00020000
  s_mov_b32 s56, s66
  s_and_b32 s57, s67, 0xffff
  s_mov_b32 s58, 0x100
  s_mov_b32 s59, 0x00020000
  s_mov_b32 s66, s64
  s_mov_b32 s67, s65
  v_mov_b32 v215, 0
  s_lshl_b32 s20, s2, 2
  s_add_u32 s20, s20, s17
  s_cmp_eq_u32 s20, 0
  s_cbranch_scc0 P1_NOTAG
  s_mov_b64 exec, 1
  s_nop 0
  v_mov_b32 v13, 0x9a2000
  buffer_load_dword v16, v13, s[44:47], 0 offen sc1
  v_mov_b32 v17, 1
  s_waitcnt vmcnt(0)
  v_add_u32_e64 v16, 1, v16
  buffer_store_dwordx2 v[16:17], v8, s[56:59], 0 offen sc1
  buffer_store_dword v16, v13, s[44:47], 0 offen sc1
  s_mov_b64 exec, -1
P1_NOTAG:
  s_cmp_eq_u32 s17, 1
  s_cbranch_scc0 P1_NOCLR
  s_mul_i32 s20, s2, 288
  s_add_u32 s20, s20, 0x980000
  s_mov_b64 exec, 0x3ffff
  buffer_store_dwordx4 v[8:11], v6, s[44:47], s20 offen sc1
  s_mov_b64 exec, -1
P1_NOCLR:
  buffer_load_dwordx4 v[52:55], v6, s[24:27], 0 offen offset:0
  buffer_load_dwordx2 v[50:51], v4, s[24:27], 0 offen offset:0
  buffer_load_dwordx4 v[60:63], v6, s[24:27], 0 offen offset:1024
  buffer_load_dwordx2 v[58:59], v6, s[24:27], 0 offen offset:1016
  buffer_load_dwordx4 v[68:71], v6, s[24:27], 0 offen offset:2048
  buffer_load_dwordx2 v[66:67], v6, s[24:27], 0 offen offset:2040
  buffer_load_dwordx4 v[76:79], v6, s[24:27], 0 offen offset:3072
  buffer_load_dwordx2 v[74:75], v6, s[24:27], 0 offen offset:3064
  s_mov_b64 exec, 7
  buffer_load_dwordx4 v[84:87], v5, s[24:27], 0 offen
  buffer_load_dwordx2 v[82:83], v7, s[24:27], 0 offen
  s_mov_b64 exec, -1
  s_barrier
  s_mul_i32 s20, s17, 16640
  s_add_u32 s20, s20, 45088
  v_add_u32 v14, s20, v6
  v_add_u32 v15, s20, v5
  s_getpc_b64 s[62:63]
CPF_1:
  s_and_b32 s62, s62, 0xfffffff0
  s_lshr_b32 s64, s2, 3
  s_lshl_b32 s64, s64, 10
  v_lshlrev_b32 v144, 4, v1
  v_add_u32_e64 v144, s64, v144
  v_min_u32 v152, (MK_END-CPF_1-32)&0xfffffff0, v144
  global_load_dwordx4 v[148:151], v152, s[62:63]
  v_add_u32 v144, 0x8000, v144
  v_min_u32 v152, (MK_END-CPF_1-32)&0xfffffff0, v144
  global_load_dwordx4 v[148:151], v152, s[62:63]
  s_cmp_eq_u32 s17, 1
  s_cbranch_scc0 P1_NOARR
  s_waitcnt vmcnt(12)
  s_mov_b64 exec, 1
  ds_add_rtn_u32 v216, v219, v221 offset:8
  s_waitcnt lgkmcnt(0)
  v_readfirstlane_b32 s20, v216
  s_mov_b64 exec, -1
  s_cmp_eq_u32 s20, 4
  s_cbranch_scc0 P1_L_N
  s_mov_b32 s3, 0
  v_mov_b32_e64 v213, 0
P1_L_T:
  v_readfirstlane_b32 s20, v215
  s_add_u32 s3, s3, 1
  s_cmp_eq_u32 s20, 1
  s_cbranch_scc1 P1_L_T_G
  s_cmp_ge_u32 s3, 0x200000
  s_cbranch_scc1 P1_L_T_G
  buffer_load_dwordx2 v[214:215], v213, s[56:59], 0 offen sc1
  s_waitcnt vmcnt(0)
  s_branch P1_L_T
P1_L_T_G:
  s_lshl_b32 s20, s2, 4
  s_add_u32 s20, s20, 0x99a000
  v_lshlrev_b32 v216, 12, v1
  v_add_u32 v216, s20, v216
  s_mov_b64 exec, 0xff
  buffer_store_dword v214, v216, s[44:47], 0 offen sc1
  s_mov_b64 exec, -1
P1_L_N:
P1_NOARR:
  s_waitcnt vmcnt(0)
  v_alignbit_b32 v88, v52, v51, 16
  v_alignbit_b32 v89, v53, v52, 16
  v_alignbit_b32 v90, v54, v53, 16
  v_alignbit_b32 v91, v55, v54, 16
  v_mov_b32 v92, v51
  v_mov_b32 v93, v52
  v_mov_b32 v94, v53
  v_mov_b32 v95, v54
  v_alignbit_b32 v96, v51, v50, 16
  v_alignbit_b32 v97, v52, v51, 16
  v_alignbit_b32 v98, v53, v52, 16
  v_alignbit_b32 v99, v54, v53, 16
  ds_write_b128 v14, v[52:55] offset:0
  ds_write_b128 v14, v[88:91] offset:4160
  ds_write_b128 v14, v[92:95] offset:8320
  ds_write_b128 v14, v[96:99] offset:12480
  v_alignbit_b32 v100, v60, v59, 16
  v_alignbit_b32 v101, v61, v60, 16
  v_alignbit_b32 v102, v62, v61, 16
  v_alignbit_b32 v103, v63, v62, 16
  v_mov_b32 v104, v59
  v_mov_b32 v105, v60
  v_mov_b32 v106, v61
  v_mov_b32 v107, v62
  v_alignbit_b32 v108, v59, v58, 16
  v_alignbit_b32 v109, v60, v59, 16
  v_alignbit_b32 v110, v61, v60, 16
  v_alignbit_b32 v111, v62, v61, 16
  ds_write_b128 v14, v[60:63] offset:1024
  ds_write_b128 v14, v[100:103] offset:5184
  ds_write_b128 v14, v[104:107] offset:9344
  ds_write_b128 v14, v[108:111] offset:13504
  v_alignbit_b32 v88, v68, v67, 16
  v_alignbit_b32 v89, v69, v68, 16
  v_alignbit_b32 v90, v70, v69, 16
  v_alignbit_b32 v91, v71, v70, 16
  v_mov_b32 v92, v67
  v_mov_b32 v93, v68
  v_mov_b32 v94, v69
  v_mov_b32 v95, v70
  v_alignbit_b32 v96, v67, v66, 16
  v_alignbit_b32 v97, v68, v67, 16
  v_alignbit_b32 v98, v69, v68, 16
  v_alignbit_b32 v99, v70, v69, 16
  ds_write_b128 v14, v[68:71] offset:2048
  ds_write_b128 v14, v[88:91] offset:6208
  ds_write_b128 v14, v[92:95] offset:10368
  ds_write_b128 v14, v[96:99] offset:14528
  v_alignbit_b32 v100, v76, v75, 16
  v_alignbit_b32 v101, v77, v76, 16
  v_alignbit_b32 v102, v78, v77, 16
  v_alignbit_b32 v103, v79, v78, 16
  v_mov_b32 v104, v75
  v_mov_b32 v105, v76
  v_mov_b32 v106, v77
  v_mov_b32 v107, v78
  v_alignbit_b32 v108, v75, v74, 16
  v_alignbit_b32 v109, v76, v75, 16
  v_alignbit_b32 v110, v77, v76, 16
  v_alignbit_b32 v111, v78, v77, 16
  ds_write_b128 v14, v[76:79] offset:3072
  ds_write_b128 v14, v[100:103] offset:7232
  ds_write_b128 v14, v[104:107] offset:11392
  ds_write_b128 v14, v[108:111] offset:15552
  s_mov_b64 exec, 7
  s_nop 0
  v_alignbit_b32 v88, v84, v83, 16
  v_alignbit_b32 v89, v85, v84, 16
  v_alignbit_b32 v90, v86, v85, 16
  v_alignbit_b32 v91, v87, v86, 16
  v_mov_b32 v92, v83
  v_mov_b32 v93, v84
  v_mov_b32 v94, v85
  v_mov_b32 v95, v86
  v_alignbit_b32 v96, v83, v82, 16
  v_alignbit_b32 v97, v84, v83, 16
  v_alignbit_b32 v98, v85, v84, 16
  v_alignbit_b32 v99, v86, v85, 16
  ds_write_b128 v15, v[84:87] offset:0
  ds_write_b128 v15, v[88:91] offset:4160
  ds_write_b128 v15, v[92:95] offset:8320
  ds_write_b128 v15, v[96:99] offset:12480
  s_mov_b64 exec, -1
  v_lshrrev_b32 v2, 4, v1
  v_and_b32 v3, 3, v1
  v_xor_b32 v2, v2, v3
  s_lshl_b32 s21, s14, 2
  v_add_u32 v2, s21, v2
  v_lshrrev_b32 v4, 2, v1
  s_lshl_b32 s20, s17, 6
  s_sub_u32 s20, 207, s20
  v_sub_u32 v3, s20, v4
  s_lshl_b32 s20, s15, 12
  s_lshl_b32 s21, s17, 6
  v_add_u32 v3, s21, v4
  v_lshl_add_u32 v4, v3, 3, v2
  v_and_b32 v4, 255, v4
  v_lshlrev_b32 v4, 4, v4
  v_lshlrev_b32 v5, 14, v3
  v_add3_u32 v4, v4, v5, s20
  v_xor_b32 v7, 2048, v4
  s_and_b32 s20, s17, 1
  s_lshl_b32 s20, s20, 10
  s_add_u32 s20, s20, 128000
  v_add_u32_e64 v12, s20, v6
  ds_write_b128 v12, v[8:11]
  s_mov_b32 s40, s6
  s_and_b32 s41, s7, 0xffff
  s_mov_b32 s42, 0x700000
  s_mov_b32 s43, 0x00020000
  s_and_b32 s20, s2, 31
  s_mul_i32 s20, s20, 28
  s_mul_i32 s21, s17, 7
  s_add_u32 s26, s20, s21
  s_lshr_b32 s27, s2, 5
  s_lshl_b32 s32, s26, 13
  s_lshl_b32 s21, s27, 8
  s_add_u32 s32, s32, s21
  s_mul_i32 s27, s27, 1146880
  s_add_u32 s27, s27, 0x3000000
  v_lshrrev_b32 v12, 4, v1
  v_and_b32 v13, 15, v1
  v_lshlrev_b32 v2, 1, v12
  v_xor_b32 v13, v13, v2
  v_lshlrev_b32 v13, 4, v13
  v_lshl_add_u32 v12, v12, 11, v13
  v_mov_b32_e64 v170, v12
  s_mov_b32 s64, s32
  s_lshr_b32 s50, s26, 3
  s_mul_i32 s51, s50, 147
  s_lshr_b32 s51, s51, 10
  s_mul_i32 s52, s51, 7
  s_sub_u32 s50, s50, s52
  s_and_b32 s52, s51, 7
  s_lshr_b32 s51, s51, 3
  s_mul_i32 s51, s51, 56
  s_and_b32 s53, s50, 3
  s_lshl_b32 s53, s53, 4
  s_lshr_b32 s54, s50, 2
  s_add_u32 s53, s53, s54
  s_lshl_b32 s54, s52, 1
  s_add_u32 s53, s53, s54
  s_and_b32 s55, s26, 7
  s_and_b32 s54, s26, 1
  s_lshl_b32 s54, s54, 2
  s_lshr_b32 s49, s55, 1
  s_add_u32 s54, s54, s49
  s_add_u32 s52, s52, 48
  s_cmp_eq_u32 s50, 3
  s_cselect_b32 s53, s52, s53
  s_cselect_b32 s55, s54, s55
  s_add_u32 s51, s51, s53
  s_mul_i32 s51, s51, 10240
  s_add_u32 s94, s51, s27
  s_add_u32 s26, s26, 1
  s_lshl_b32 s54, s55, 3
  v_lshrrev_b32 v2, 3, v1
  v_add_u32 v2, s54, v2
  v_add_u32 v3, 4, v2
  v_mul_u32_u24 v3, 37, v3
  v_lshrrev_b32 v3, 8, v3
  v_add_lshl_u32 v171, v2, v3, 7
  v_and_b32_e64 v2, 7, v1
  v_lshl_add_u32 v171, v2, 4, v171
  s_and_b32 s55, s55, 1
  s_lshl_b32 s55, s55, 7
  v_xor_b32_e64 v13, s55, v12
  buffer_load_dwordx4 v[112:115], v13, s[40:43], s32 offen
  s_add_u32 s32, s32, 8192
  s_lshr_b32 s50, s26, 3
  s_mul_i32 s51, s50, 147
  s_lshr_b32 s51, s51, 10
  s_mul_i32 s52, s51, 7
  s_sub_u32 s50, s50, s52
  s_and_b32 s52, s51, 7
  s_lshr_b32 s51, s51, 3
  s_mul_i32 s51, s51, 56
  s_and_b32 s53, s50, 3
  s_lshl_b32 s53, s53, 4
  s_lshr_b32 s54, s50, 2
  s_add_u32 s53, s53, s54
  s_lshl_b32 s54, s52, 1
  s_add_u32 s53, s53, s54
  s_and_b32 s55, s26, 7
  s_and_b32 s54, s26, 1
  s_lshl_b32 s54, s54, 2
  s_lshr_b32 s49, s55, 1
  s_add_u32 s54, s54, s49
  s_add_u32 s52, s52, 48
  s_cmp_eq_u32 s50, 3
  s_cselect_b32 s53, s52, s53
  s_cselect_b32 s55, s54, s55
  s_add_u32 s51, s51, s53
  s_mul_i32 s51, s51, 10240
  s_add_u32 s95, s51, s27
  s_add_u32 s26, s26, 1
  s_lshl_b32 s54, s55, 3
  v_lshrrev_b32 v2, 3, v1
  v_add_u32 v2, s54, v2
  v_add_u32 v3, 4, v2
  v_mul_u32_u24 v3, 37, v3
  v_lshrrev_b32_e64 v3, 8, v3
  v_add_lshl_u32 v172, v2, v3, 7
  v_and_b32_e64 v2, 7, v1
  v_lshl_add_u32 v172, v2, 4, v172
  s_and_b32 s55, s55, 1
  s_lshl_b32 s55, s55, 7
  v_xor_b32_e64 v13, s55, v12
  buffer_load_dwordx4 v[116:119], v13, s[40:43], s32 offen
  s_add_u32 s32, s32, 8192
  s_lshr_b32 s50, s26, 3
  s_mul_i32 s51, s50, 147
  s_lshr_b32 s51, s51, 10
  s_mul_i32 s52, s51, 7
  s_sub_u32 s50, s50, s52
  s_and_b32 s52, s51, 7
  s_lshr_b32 s51, s51, 3
  s_mul_i32 s51, s51, 56
  s_and_b32 s53, s50, 3
  s_lshl_b32 s53, s53, 4
  s_lshr_b32 s54, s50, 2
  s_add_u32 s53, s53, s54
  s_lshl_b32 s54, s52, 1
  s_add_u32 s53, s53, s54
  s_and_b32 s55, s26, 7
  s_and_b32 s54, s26, 1
  s_lshl_b32 s54, s54, 2
  s_lshr_b32 s49, s55, 1
  s_add_u32 s54, s54, s49
  s_add_u32 s52, s52, 48
  s_cmp_eq_u32 s50, 3
  s_cselect_b32 s53, s52, s53
  s_cselect_b32 s55, s54, s55
  s_add_u32 s51, s51, s53
  s_mul_i32 s51, s51, 10240
  s_add_u32 s96, s51, s27
  s_add_u32 s26, s26, 1
  s_lshl_b32 s54, s55, 3
  v_lshrrev_b32 v2, 3, v1
  v_add_u32 v2, s54, v2
  v_add_u32 v3, 4, v2
  v_mul_u32_u24 v3, 37, v3
  v_lshrrev_b32_e64 v3, 8, v3
  v_add_lshl_u32 v173, v2, v3, 7
  v_and_b32_e64 v2, 7, v1
  v_lshl_add_u32 v173, v2, 4, v173
  s_and_b32 s55, s55, 1
  s_lshl_b32 s55, s55, 7
  v_xor_b32_e64 v13, s55, v12
  buffer_load_dwordx4 v[120:123], v13, s[40:43], s32 offen
  s_add_u32 s32, s32, 8192
  s_lshr_b32 s50, s26, 3
  s_mul_i32 s51, s50, 147
  s_lshr_b32 s51, s51, 10
  s_mul_i32 s52, s51, 7
  s_sub_u32 s50, s50, s52
  s_and_b32 s52, s51, 7
  s_lshr_b32 s51, s51, 3
  s_mul_i32 s51, s51, 56
  s_and_b32 s53, s50, 3
  s_lshl_b32 s53, s53, 4
  s_lshr_b32 s54, s50, 2
  s_add_u32 s53, s53, s54
  s_lshl_b32 s54, s52, 1
  s_add_u32 s53, s53, s54
  s_and_b32 s55, s26, 7
  s_and_b32 s54, s26, 1
  s_lshl_b32 s54, s54, 2
  s_lshr_b32 s49, s55, 1
  s_add_u32 s54, s54, s49
  s_add_u32 s52, s52, 48
  s_cmp_eq_u32 s50, 3
  s_cselect_b32 s53, s52, s53
  s_cselect_b32 s55, s54, s55
  s_add_u32 s51, s51, s53
  s_mul_i32 s51, s51, 10240
  s_add_u32 s97, s51, s27
  s_add_u32 s26, s26, 1
  s_lshl_b32 s54, s55, 3
  v_lshrrev_b32 v2, 3, v1
  v_add_u32 v2, s54, v2
  v_add_u32 v3, 4, v2
  v_mul_u32_u24 v3, 37, v3
  v_lshrrev_b32_e64 v3, 8, v3
  v_add_lshl_u32 v174, v2, v3, 7
  v_and_b32_e64 v2, 7, v1
  v_lshl_add_u32 v174, v2, 4, v174
  s_and_b32 s55, s55, 1
  s_lshl_b32 s55, s55, 7
  v_xor_b32_e64 v13, s55, v12
  buffer_load_dwordx4 v[124:127], v13, s[40:43], s32 offen
  s_add_u32 s32, s32, 8192
  s_lshr_b32 s50, s26, 3
  s_mul_i32 s51, s50, 147
  s_lshr_b32 s51, s51, 10
  s_mul_i32 s52, s51, 7
  s_sub_u32 s50, s50, s52
  s_and_b32 s52, s51, 7
  s_lshr_b32 s51, s51, 3
  s_mul_i32 s51, s51, 56
  s_and_b32 s53, s50, 3
  s_lshl_b32 s53, s53, 4
  s_lshr_b32 s54, s50, 2
  s_add_u32 s53, s53, s54
  s_lshl_b32 s54, s52, 1
  s_add_u32 s53, s53, s54
  s_and_b32 s55, s26, 7
  s_and_b32 s54, s26, 1
  s_lshl_b32 s54, s54, 2
  s_lshr_b32 s49, s55, 1
  s_add_u32 s54, s54, s49
  s_add_u32 s52, s52, 48
  s_cmp_eq_u32 s50, 3
  s_cselect_b32 s53, s52, s53
  s_cselect_b32 s55, s54, s55
  s_add_u32 s51, s51, s53
  s_mul_i32 s51, s51, 10240
  s_add_u32 s98, s51, s27
  s_add_u32 s26, s26, 1
  s_lshl_b32 s54, s55, 3
  v_lshrrev_b32 v2, 3, v1
  v_add_u32 v2, s54, v2
  v_add_u32 v3, 4, v2
  v_mul_u32_u24 v3, 37, v3
  v_lshrrev_b32_e64 v3, 8, v3
  v_add_lshl_u32 v175, v2, v3, 7
  v_and_b32_e64 v2, 7, v1
  v_lshl_add_u32 v175, v2, 4, v175
  s_and_b32 s55, s55, 1
  s_lshl_b32 s55, s55, 7
  v_xor_b32_e64 v13, s55, v12
  buffer_load_dwordx4 v[128:131], v13, s[40:43], s32 offen
  s_add_u32 s32, s32, 8192
  s_lshr_b32 s50, s26, 3
  s_mul_i32 s51, s50, 147
  s_lshr_b32 s51, s51, 10
  s_mul_i32 s52, s51, 7
  s_sub_u32 s50, s50, s52
  s_and_b32 s52, s51, 7
  s_lshr_b32 s51, s51, 3
  s_mul_i32 s51, s51, 56
  s_and_b32 s53, s50, 3
  s_lshl_b32 s53, s53, 4
  s_lshr_b32 s54, s50, 2
  s_add_u32 s53, s53, s54
  s_lshl_b32 s54, s52, 1
  s_add_u32 s53, s53, s54
  s_and_b32 s55, s26, 7
  s_and_b32 s54, s26, 1
  s_lshl_b32 s54, s54, 2
  s_lshr_b32 s49, s55, 1
  s_add_u32 s54, s54, s49
  s_add_u32 s52, s52, 48
  s_cmp_eq_u32 s50, 3
  s_cselect_b32 s53, s52, s53
  s_cselect_b32 s55, s54, s55
  s_add_u32 s51, s51, s53
  s_mul_i32 s51, s51, 10240
  s_add_u32 s99, s51, s27
  s_add_u32 s26, s26, 1
  s_lshl_b32 s54, s55, 3
  v_lshrrev_b32 v2, 3, v1
  v_add_u32 v2, s54, v2
  v_add_u32 v3, 4, v2
  v_mul_u32_u24 v3, 37, v3
  v_lshrrev_b32_e64 v3, 8, v3
  v_add_lshl_u32 v176, v2, v3, 7
  v_and_b32_e64 v2, 7, v1
  v_lshl_add_u32 v176, v2, 4, v176
  s_and_b32 s55, s55, 1
  s_lshl_b32 s55, s55, 7
  v_xor_b32_e64 v13, s55, v12
  buffer_load_dwordx4 v[132:135], v13, s[40:43], s32 offen
  s_add_u32 s32, s32, 8192
  s_lshr_b32 s50, s26, 3
  s_mul_i32 s51, s50, 147
  s_lshr_b32 s51, s51, 10
  s_mul_i32 s52, s51, 7
  s_sub_u32 s50, s50, s52
  s_and_b32 s52, s51, 7
  s_lshr_b32 s51, s51, 3
  s_mul_i32 s51, s51, 56
  s_and_b32 s53, s50, 3
  s_lshl_b32 s53, s53, 4
  s_lshr_b32 s54, s50, 2
  s_add_u32 s53, s53, s54
  s_lshl_b32 s54, s52, 1
  s_add_u32 s53, s53, s54
  s_and_b32 s55, s26, 7
  s_and_b32 s54, s26, 1
  s_lshl_b32 s54, s54, 2
  s_lshr_b32 s49, s55, 1
  s_add_u32 s54, s54, s49
  s_add_u32 s52, s52, 48
  s_cmp_eq_u32 s50, 3
  s_cselect_b32 s53, s52, s53
  s_cselect_b32 s55, s54, s55
  s_add_u32 s51, s51, s53
  s_mul_i32 s51, s51, 10240
  s_add_u32 s100, s51, s27
  s_add_u32 s26, s26, 1
  s_lshl_b32 s54, s55, 3
  v_lshrrev_b32 v2, 3, v1
  v_add_u32 v2, s54, v2
  v_add_u32 v3, 4, v2
  v_mul_u32_u24 v3, 37, v3
  v_lshrrev_b32_e64 v3, 8, v3
  v_add_lshl_u32 v177, v2, v3, 7
  v_and_b32_e64 v2, 7, v1
  v_lshl_add_u32 v177, v2, 4, v177
  s_and_b32 s55, s55, 1
  s_lshl_b32 s55, s55, 7
  v_xor_b32_e64 v13, s55, v12
  buffer_load_dwordx4 v[136:139], v13, s[40:43], s32 offen
  s_add_u32 s32, s32, 8192
  s_waitcnt lgkmcnt(0)
  s_barrier
  s_cmp_eq_u32 s17, 2
  s_cbranch_scc0 P1_W2
  s_mov_b32 s3, 0
  v_mov_b32 v213, 0
P1_T2:
  v_readfirstlane_b32 s20, v215
  s_add_u32 s3, s3, 1
  s_cmp_eq_u32 s20, 1
  s_cbranch_scc1 P1_T2_G
  s_cmp_ge_u32 s3, 0x200000
  s_cbranch_scc1 P1_T2_G
  buffer_load_dwordx2 v[214:215], v213, s[56:59], 0 offen sc1
  s_waitcnt vmcnt(0)
  s_branch P1_T2
P1_T2_G:
  v_readfirstlane_b32 s65, v214
  s_and_b32 s21, s2, 7
  s_lshl_b32 s21, s21, 12
  s_add_u32 s21, s21, 0x99a000
  v_add_u32 v12, s21, v6
  s_mov_b32 s23, 0
P1_P2:
  buffer_load_dword v20, v12, s[44:47], 0 offen offset:0 sc1
  buffer_load_dword v21, v12, s[44:47], 0 offen offset:1024 sc1
  buffer_load_dword v22, v12, s[44:47], 0 offen offset:2048 sc1
  buffer_load_dword v23, v12, s[44:47], 0 offen offset:3072 sc1
  s_waitcnt vmcnt(0)
  v_cmp_eq_u32 vcc, s65, v20
  s_nop 1
  s_nop 0
  v_cndmask_b32 v20, 0, 1, vcc
  v_cmp_eq_u32 vcc, s65, v21
  s_nop 1
  v_cndmask_b32 v21, 0, 1, vcc
  v_cmp_eq_u32 vcc, s65, v22
  s_nop 1
  v_cndmask_b32 v22, 0, 1, vcc
  v_cmp_eq_u32 vcc, s65, v23
  s_nop 1
  v_cndmask_b32 v23, 0, 1, vcc
  v_and_b32_e64 v20, v20, v21
  v_bitop3_b32 v20, v20, v22, v23 bitop3:0x80
  v_cmp_eq_u32 vcc, 0, v20
  s_add_u32 s23, s23, 1
  s_cmp_ge_u32 s23, 0x200000
  s_cbranch_scc1 P1_P2_GOT
  s_cmp_eq_u64 vcc, 0
  s_cbranch_scc1 P1_P2_GOT
  s_sleep 4
  s_branch P1_P2
P1_P2_GOT:
  s_mov_b64 exec, -1
  ds_write_b32 v219, v221 offset:52
P1_W2:
  v_add_u32_e64 v13, 52, v219
P1_Q2:
  ds_read_b32 v20, v13
  s_waitcnt lgkmcnt(0)
  v_readfirstlane_b32 s20, v20
  s_nop 0
  s_cmp_ge_u32 s20, 1
  s_cbranch_scc1 P1_Q2_GO
  s_sleep 2
  s_branch P1_Q2
P1_Q2_GO:
  s_lshl_b32 s20, s17, 12
  s_add_u32 m0, s20, 130048
  s_mov_b32 s21, 0x400000
  buffer_load_dwordx4 v4, s[44:47], s21 offen sc1 lds
  s_add_u32 m0, s20, 131072
  s_mov_b32 s21, 0x440000
  buffer_load_dwordx4 v7, s[44:47], s21 offen sc1 lds
  s_add_u32 m0, s20, 132096
  s_mov_b32 s21, 0x480000
  buffer_load_dwordx4 v4, s[44:47], s21 offen sc1 lds
  s_add_u32 m0, s20, 133120
  s_mov_b32 s21, 0x4c0000
  buffer_load_dwordx4 v7, s[44:47], s21 offen sc1 lds
  s_add_u32 m0, s20, 146432
  s_add_u32 s21, s20, 0x800000
  buffer_load_dwordx4 v6, s[44:47], s21 offen offset:0 sc1 lds
  buffer_load_dwordx4 v6, s[44:47], s21 offen offset:1024 sc1 lds
  buffer_load_dwordx4 v6, s[44:47], s21 offen offset:2048 sc1 lds
  buffer_load_dwordx4 v6, s[44:47], s21 offen offset:3072 sc1 lds
  s_mov_b32 s36, s4
  s_and_b32 s37, s5, 0xffff
  s_mov_b32 s38, 0x700000
  s_mov_b32 s39, 0x00020000
  s_and_b32 s8, s2, 7
  s_lshr_b32 s9, s2, 3
  s_and_b32 s14, s8, 1
  s_lshl_b32 s14, s14, 3
  s_lshr_b32 s15, s9, 2
  s_add_u32 s14, s14, s15
  s_lshr_b32 s15, s8, 1
  s_lshl_b32 s15, s15, 2
  s_and_b32 s9, s9, 3
  s_add_u32 s15, s15, s9
  s_mov_b32 s30, 45056
  s_mov_b32 s31, 4294877184
  s_and_b32 s18, s17, 1
  s_mul_i32 s20, s15, 448
  s_mul_i32 s21, s18, 229376
  s_add_u32 s20, s20, s21
  s_mov_b32 s22, 0x924924a
  v_add_u32 v2, 0, v1
  v_mul_hi_u32 v3, v2, s22
  v_mul_u32_u24 v5, 28, v3
  v_sub_u32 v2, v2, v5
  v_lshrrev_b32 v5, 1, v3
  v_and_b32 v5, 2, v5
  v_xor_b32 v2, v2, v5
  v_lshlrev_b32 v2, 4, v2
  v_mul_u32_u24 v3, 7168, v3
  v_add3_u32 v96, v3, v2, s20
  v_add_u32_e64 v2, 64, v1
  v_mul_hi_u32 v3, v2, s22
  v_mul_u32_u24 v5, 28, v3
  v_sub_u32 v2, v2, v5
  v_lshrrev_b32 v5, 1, v3
  v_and_b32 v5, 2, v5
  v_xor_b32 v2, v2, v5
  v_lshlrev_b32 v2, 4, v2
  v_mul_u32_u24 v3, 7168, v3
  v_add3_u32 v97, v3, v2, s20
  v_add_u32 v2, 128, v1
  v_mul_hi_u32 v3, v2, s22
  v_mul_u32_u24 v5, 28, v3
  v_sub_u32 v2, v2, v5
  v_lshrrev_b32 v5, 1, v3
  v_and_b32 v5, 2, v5
  v_xor_b32 v2, v2, v5
  v_lshlrev_b32 v2, 4, v2
  v_mul_u32_u24 v3, 7168, v3
  v_add3_u32 v98, v3, v2, s20
  v_add_u32 v2, 192, v1
  v_mul_hi_u32 v3, v2, s22
  v_mul_u32_u24 v5, 28, v3
  v_sub_u32 v2, v2, v5
  v_lshrrev_b32 v5, 1, v3
  v_and_b32 v5, 2, v5
  v_xor_b32 v2, v2, v5
  v_lshlrev_b32 v2, 4, v2
  v_mul_u32_u24 v3, 7168, v3
  v_add3_u32 v99, v3, v2, s20
  v_add_u32 v2, 256, v1
  v_mul_hi_u32 v3, v2, s22
  v_mul_u32_u24 v5, 28, v3
  v_sub_u32 v2, v2, v5
  v_lshrrev_b32 v5, 1, v3
  v_and_b32 v5, 2, v5
  v_xor_b32 v2, v2, v5
  v_lshlrev_b32 v2, 4, v2
  v_mul_u32_u24 v3, 7168, v3
  v_add3_u32 v100, v3, v2, s20
  v_add_u32 v2, 320, v1
  v_mul_hi_u32 v3, v2, s22
  v_mul_u32_u24 v5, 28, v3
  v_sub_u32 v2, v2, v5
  v_lshrrev_b32 v5, 1, v3
  v_and_b32 v5, 2, v5
  v_xor_b32 v2, v2, v5
  v_lshlrev_b32 v2, 4, v2
  v_mul_u32_u24 v3, 7168, v3
  v_add3_u32 v101, v3, v2, s20
  v_add_u32 v2, 384, v1
  v_mul_hi_u32 v3, v2, s22
  v_mul_u32_u24 v5, 28, v3
  v_sub_u32 v2, v2, v5
  v_lshrrev_b32 v5, 1, v3
  v_and_b32 v5, 2, v5
  v_xor_b32 v2, v2, v5
  v_lshlrev_b32 v2, 4, v2
  v_mul_u32_u24 v3, 7168, v3
  v_add3_u32 v102, v3, v2, s20
  s_lshr_b32 s21, s17, 1
  s_mul_i32 s24, s14, 458752
  s_mul_i32 s25, s21, 114688
  s_add_u32 s24, s24, s25
  s_mul_i32 s25, s18, 22528
  s_mul_i32 s21, s21, 7168
  s_add_u32 s25, s25, s21
  s_add_u32 m0, s25, 8192
  s_nop 0
  buffer_load_dwordx4 v96, s[36:39], s24 offen lds
  s_add_u32 m0, m0, 1024
  s_nop 0
  buffer_load_dwordx4 v97, s[36:39], s24 offen lds
  s_add_u32 m0, m0, 1024
  s_nop 0
  buffer_load_dwordx4 v98, s[36:39], s24 offen lds
  s_add_u32 m0, m0, 1024
  s_nop 0
  buffer_load_dwordx4 v99, s[36:39], s24 offen lds
  s_add_u32 m0, m0, 1024
  s_nop 0
  buffer_load_dwordx4 v100, s[36:39], s24 offen lds
  s_add_u32 m0, m0, 1024
  s_nop 0
  buffer_load_dwordx4 v101, s[36:39], s24 offen lds
  s_add_u32 m0, m0, 1024
  s_nop 0
  buffer_load_dwordx4 v102, s[36:39], s24 offen lds
  v_mov_b32 v7, 162856
  v_mov_b32_e64 v14, 1
  s_waitcnt vmcnt(7)
  s_mov_b64 exec, 1
  ds_add_u32 v7, v14
  s_mov_b64 exec, -1
  s_lshl_b32 s20, s2, 14
  s_lshl_b32 s21, s17, 12
  s_add_u32 s20, s20, s21
  s_add_u32 s20, s20, 0x2200000
  buffer_store_dwordx4 v[8:11], v6, s[44:47], s20 offen offset:0 sc1
  buffer_store_dwordx4 v[8:11], v6, s[44:47], s20 offen offset:1024 sc1
  buffer_store_dwordx4 v[8:11], v6, s[44:47], s20 offen offset:2048 sc1
  buffer_store_dwordx4 v[8:11], v6, s[44:47], s20 offen offset:3072 sc1
  s_and_b32 s52, s15, 12
  s_and_b32 s53, s15, 3
  s_sub_u32 s21, s14, s52
  s_and_b32 s21, s21, 15
  s_cmp_lt_u32 s21, s53
  s_cselect_b32 s21, 0, 1
  s_add_u32 s53, s53, s21
  s_cmp_eq_u32 s14, s15
  s_cselect_b32 s53, 0, s53
  s_cmp_eq_u32 s52, s14
  s_addc_u32 s52, s52, 0
  v_lshrrev_b32 v2, 4, v1
  v_bfe_u32 v3, v1, 2, 2
  v_and_b32 v4, 3, v1
  v_and_b32 v5, 1, v2
  v_lshrrev_b32 v20, 2, v1
  v_and_b32 v21, 7, v20
  v_lshlrev_b32 v21, 1, v21
  s_lshl_b32 s21, s17, 2
  v_add_u32 v22, s21, v4
  v_xor_b32 v21, v21, v22
  v_lshlrev_b32_e64 v21, 4, v21
  v_lshl_add_u32 v168, v20, 8, v21
  s_sub_u32 s22, s53, 3
  s_cmp_ge_u32 s53, 3
  s_cselect_b32 s22, s22, s53
  s_mul_i32 s22, s22, 45056
  v_add_u32 v168, s22, v168
  s_lshl_b32 s21, s14, 2
  s_add_u32 s21, s21, s17
  s_lshl_b32 s21, s21, 4
  s_add_u32 s21, s21, s15
  s_lshl_b32 s21, s21, 8
  s_add_u32 s21, s21, 0x9c0000
  v_lshlrev_b32 v21, 6, v2
  v_lshlrev_b32_e64 v22, 4, v4
  v_add3_u32 v169, v21, v22, s21
  s_mov_b32 s33, 0xffff0000
  s_getpc_b64 s[60:61]
A_PC:
  s_add_u32 s60, s60, A_SUB0-A_PC
  s_addc_u32 s61, s61, 0
  s_branch A_SKIP
A_SUB0:
A_SS_0:
  s_cmp_eq_u32 s55, 0
  s_cbranch_scc0 A_SS_1
  ds_read_b128 v[24:27], v168 offset:0
  ds_read_b128 v[28:31], v168 offset:4096
  ds_read_b128 v[32:35], v168 offset:22528
  ds_read_b128 v[36:39], v168 offset:26624
  s_waitcnt lgkmcnt(0)
  s_branch A_SS_E
A_SS_1:
  s_cmp_eq_u32 s55, 1
  s_cbranch_scc0 A_SS_2
  v_lshlrev_b32 v64, 16, v24
  v_and_b32 v65, s33, v24
  v_lshlrev_b32 v66, 16, v25
  v_and_b32 v67, s33, v25
  v_lshlrev_b32 v68, 16, v26
  v_and_b32 v69, s33, v26
  v_lshlrev_b32 v70, 16, v27
  v_and_b32 v71, s33, v27
  v_mul_f32 v72, v64, v64
  v_mul_f32 v73, v65, v65
  v_mul_f32 v74, v66, v66
  v_mul_f32 v75, v67, v67
  v_mul_f32 v76, v68, v68
  v_mul_f32 v77, v69, v69
  v_mul_f32 v78, v70, v70
  v_mul_f32 v79, v71, v71
  v_lshlrev_b32 v56, 16, v28
  v_and_b32 v57, s33, v28
  v_lshlrev_b32 v58, 16, v29
  v_and_b32 v59, s33, v29
  v_lshlrev_b32 v60, 16, v30
  v_and_b32 v61, s33, v30
  v_lshlrev_b32 v62, 16, v31
  v_and_b32 v63, s33, v31
  v_add_f32 v64, v64, v56
  v_fmac_f32 v72, v56, v56
  v_add_f32 v65, v65, v57
  v_fmac_f32 v73, v57, v57
  v_add_f32 v66, v66, v58
  v_fmac_f32 v74, v58, v58
  v_add_f32 v67, v67, v59
  v_fmac_f32 v75, v59, v59
  v_add_f32 v68, v68, v60
  v_fmac_f32 v76, v60, v60
  v_add_f32 v69, v69, v61
  v_fmac_f32 v77, v61, v61
  v_add_f32 v70, v70, v62
  v_fmac_f32 v78, v62, v62
  v_add_f32 v71, v71, v63
  v_fmac_f32 v79, v63, v63
  s_branch A_SS_E
A_SS_2:
  s_cmp_eq_u32 s55, 2
  s_cbranch_scc0 A_SS_3
  v_lshlrev_b32 v56, 16, v32
  v_and_b32 v57, s33, v32
  v_lshlrev_b32 v58, 16, v33
  v_and_b32 v59, s33, v33
  v_lshlrev_b32 v60, 16, v34
  v_and_b32 v61, s33, v34
  v_lshlrev_b32 v62, 16, v35
  v_and_b32 v63, s33, v35
  v_add_f32 v64, v64, v56
  v_fmac_f32 v72, v56, v56
  v_add_f32 v65, v65, v57
  v_fmac_f32 v73, v57, v57
  v_add_f32 v66, v66, v58
  v_fmac_f32 v74, v58, v58
  v_add_f32 v67, v67, v59
  v_fmac_f32 v75, v59, v59
  v_add_f32 v68, v68, v60
  v_fmac_f32 v76, v60, v60
  v_add_f32 v69, v69, v61
  v_fmac_f32 v77, v61, v61
  v_add_f32 v70, v70, v62
  v_fmac_f32 v78, v62, v62
  v_add_f32 v71, v71, v63
  v_fmac_f32 v79, v63, v63
  v_lshlrev_b32 v56, 16, v36
  v_and_b32 v57, s33, v36
  v_lshlrev_b32 v58, 16, v37
  v_and_b32 v59, s33, v37
  v_lshlrev_b32 v60, 16, v38
  v_and_b32 v61, s33, v38
  v_lshlrev_b32 v62, 16, v39
  v_and_b32 v63, s33, v39
  v_add_f32 v64, v64, v56
  v_fmac_f32 v72, v56, v56
  v_add_f32 v65, v65, v57
  v_fmac_f32 v73, v57, v57
  v_add_f32 v66, v66, v58
  v_fmac_f32 v74, v58, v58
  v_add_f32 v67, v67, v59
  v_fmac_f32 v75, v59, v59
  v_add_f32 v68, v68, v60
  v_fmac_f32 v76, v60, v60
  v_add_f32 v69, v69, v61
  v_fmac_f32 v77, v61, v61
  v_add_f32 v70, v70, v62
  v_fmac_f32 v78, v62, v62
  v_add_f32 v71, v71, v63
  v_fmac_f32 v79, v63, v63
  s_branch A_SS_E
A_SS_3:
  v_permlane32_swap_b32 v64, v72
  v_permlane32_swap_b32 v65, v73
  v_permlane32_swap_b32 v66, v74
  v_permlane32_swap_b32 v67, v75
  v_permlane32_swap_b32 v68, v76
  v_permlane32_swap_b32 v69, v77
  v_permlane32_swap_b32 v70, v78
  v_permlane32_swap_b32 v71, v79
  v_add_f32 v64, v64, v72
  v_add_f32 v65, v65, v73
  v_add_f32 v66, v66, v74
  v_add_f32 v67, v67, v75
  v_add_f32 v68, v68, v76
  v_add_f32 v69, v69, v77
  v_add_f32 v70, v70, v78
  v_add_f32 v71, v71, v79
  s_nop 1
  v_permlane16_swap_b32 v64, v68
  v_permlane16_swap_b32 v65, v69
  v_permlane16_swap_b32 v66, v70
  v_permlane16_swap_b32 v67, v71
  v_add_f32 v64, v64, v68
  v_add_f32 v65, v65, v69
  v_add_f32 v66, v66, v70
  v_add_f32 v67, v67, v71
  v_add_f32_dpp v64, v64, v64 row_ror:8 row_mask:0xf bank_mask:0xf
  v_add_f32_dpp v65, v65, v65 row_ror:8 row_mask:0xf bank_mask:0xf
  v_add_f32_dpp v66, v66, v66 row_ror:8 row_mask:0xf bank_mask:0xf
  v_add_f32_dpp v67, v67, v67 row_ror:8 row_mask:0xf bank_mask:0xf
  v_add_f32_dpp v64, v64, v64 row_ror:4 row_mask:0xf bank_mask:0xf
  v_add_f32_dpp v65, v65, v65 row_ror:4 row_mask:0xf bank_mask:0xf
  v_add_f32_dpp v66, v66, v66 row_ror:4 row_mask:0xf bank_mask:0xf
  v_add_f32_dpp v67, v67, v67 row_ror:4 row_mask:0xf bank_mask:0xf
  s_cmp_eq_u32 s57, 1
  s_cbranch_scc1 A_SS_E
  s_mov_b32 exec_lo, 0x000f000f
  s_mov_b32 exec_hi, 0x000f000f
  buffer_store_dwordx4 v[64:67], v169, s[44:47], 0 offen sc1
  s_mov_b64 exec, -1
A_SS_E:
  s_setpc_b64 s[58:59]
A_SKIP:
  s_mov_b32 s57, 1
  s_mov_b32 s55, 0
  s_swappc_b64 s[58:59], s[60:61]
  s_mov_b32 s55, 1
  s_swappc_b64 s[58:59], s[60:61]
  s_mov_b32 s55, 2
  s_swappc_b64 s[58:59], s[60:61]
  s_mov_b32 s55, 3
  s_swappc_b64 s[58:59], s[60:61]
  s_mov_b32 s57, 0
  v_lshrrev_b32 v2, 3, v1
  v_and_b32 v13, 7, v1
  s_mul_i32 s21, s17, 7
  v_add_u32 v3, s21, v13
  v_lshrrev_b32 v4, 1, v2
  v_and_b32 v4, 2, v4
  v_xor_b32_e64 v3, v3, v4
  v_mul_u32_u24 v2, 448, v2
  v_lshl_add_u32 v3, v3, 4, v2
  v_add_u32 v3, 8192, v3
  s_lshl_b32 s20, s17, 2
  s_add_u32 s20, s20, 162832
  v_mov_b32 v7, s20
  v_mov_b32_e64 v14, 1
  v_mov_b32 v15, 162832
  s_mul_i32 s20, s14, 14336
  s_mul_i32 s21, s15, 896
  s_add_u32 s20, s20, s21
  s_mul_i32 s21, s17, 224
  s_add_u32 s25, s20, s21
  s_add_u32 s25, s25, 0x900000
  v_lshrrev_b32 v2, 4, v1
  v_and_b32 v4, 1, v2
  v_lshrrev_b32 v2, 1, v2
  v_lshlrev_b32 v12, 5, v13
  v_lshl_add_u32 v12, v4, 3, v12
  v_lshl_add_u32 v12, v2, 4, v12
  s_mov_b32 s33, 0xffff0000
  s_waitcnt vmcnt(4)
  ds_write_b32 v7, v14
C_WF:
  ds_read_b128 v[48:51], v15
  s_waitcnt lgkmcnt(0)
  v_and_b32 v48, v48, v49
  v_and_b32 v50, v50, v51
  v_and_b32 v48, v48, v50
  s_nop 0
  v_readfirstlane_b32 s20, v48
  s_nop 0
  s_cmp_eq_u32 s20, 1
  s_cbranch_scc1 C_WF_GO
  s_sleep 1
  s_branch C_WF
C_WF_GO:
  ds_read_b128 v[16:19], v3 offset:0
  ds_read_b128 v[20:23], v3 offset:3584
  ds_read_b128 v[24:27], v3 offset:7168
  ds_read_b128 v[28:31], v3 offset:10752
  ds_read_b128 v[32:35], v3 offset:22528
  ds_read_b128 v[36:39], v3 offset:26112
  ds_read_b128 v[40:43], v3 offset:29696
  ds_read_b128 v[44:47], v3 offset:33280
  s_waitcnt lgkmcnt(7)
  v_lshlrev_b32 v48, 16, v16
  v_and_b32 v49, s33, v16
  v_lshlrev_b32 v50, 16, v17
  v_and_b32 v51, s33, v17
  v_lshlrev_b32 v52, 16, v18
  v_and_b32 v53, s33, v18
  v_lshlrev_b32 v54, 16, v19
  v_and_b32 v55, s33, v19
  s_waitcnt lgkmcnt(6)
  v_lshlrev_b32 v56, 16, v20
  v_and_b32 v57, s33, v20
  v_pk_add_f32 v[48:49], v[48:49], v[56:57]
  v_lshlrev_b32 v58, 16, v21
  v_and_b32 v59, s33, v21
  v_pk_add_f32 v[50:51], v[50:51], v[58:59]
  v_lshlrev_b32 v60, 16, v22
  v_and_b32 v61, s33, v22
  v_pk_add_f32 v[52:53], v[52:53], v[60:61]
  v_lshlrev_b32 v62, 16, v23
  v_and_b32 v63, s33, v23
  v_pk_add_f32 v[54:55], v[54:55], v[62:63]
  s_waitcnt lgkmcnt(5)
  v_lshlrev_b32 v56, 16, v24
  v_and_b32_e64 v57, s33, v24
  v_pk_add_f32 v[48:49], v[48:49], v[56:57]
  v_lshlrev_b32 v58, 16, v25
  v_and_b32 v59, s33, v25
  v_pk_add_f32 v[50:51], v[50:51], v[58:59]
  v_lshlrev_b32 v60, 16, v26
  v_and_b32 v61, s33, v26
  v_pk_add_f32 v[52:53], v[52:53], v[60:61]
  v_lshlrev_b32 v62, 16, v27
  v_and_b32 v63, s33, v27
  v_pk_add_f32 v[54:55], v[54:55], v[62:63]
  s_waitcnt lgkmcnt(4)
  v_lshlrev_b32 v56, 16, v28
  v_and_b32_e64 v57, s33, v28
  v_pk_add_f32 v[48:49], v[48:49], v[56:57]
  v_lshlrev_b32 v58, 16, v29
  v_and_b32 v59, s33, v29
  v_pk_add_f32 v[50:51], v[50:51], v[58:59]
  v_lshlrev_b32 v60, 16, v30
  v_and_b32 v61, s33, v30
  v_pk_add_f32 v[52:53], v[52:53], v[60:61]
  v_lshlrev_b32 v62, 16, v31
  v_and_b32 v63, s33, v31
  v_pk_add_f32 v[54:55], v[54:55], v[62:63]
  s_waitcnt lgkmcnt(3)
  v_lshlrev_b32 v56, 16, v32
  v_and_b32_e64 v57, s33, v32
  v_pk_add_f32 v[48:49], v[48:49], v[56:57]
  v_lshlrev_b32 v58, 16, v33
  v_and_b32 v59, s33, v33
  v_pk_add_f32 v[50:51], v[50:51], v[58:59]
  v_lshlrev_b32 v60, 16, v34
  v_and_b32 v61, s33, v34
  v_pk_add_f32 v[52:53], v[52:53], v[60:61]
  v_lshlrev_b32 v62, 16, v35
  v_and_b32 v63, s33, v35
  v_pk_add_f32 v[54:55], v[54:55], v[62:63]
  s_waitcnt lgkmcnt(2)
  v_lshlrev_b32 v56, 16, v36
  v_and_b32_e64 v57, s33, v36
  v_pk_add_f32 v[48:49], v[48:49], v[56:57]
  v_lshlrev_b32 v58, 16, v37
  v_and_b32 v59, s33, v37
  v_pk_add_f32 v[50:51], v[50:51], v[58:59]
  v_lshlrev_b32 v60, 16, v38
  v_and_b32 v61, s33, v38
  v_pk_add_f32 v[52:53], v[52:53], v[60:61]
  v_lshlrev_b32 v62, 16, v39
  v_and_b32 v63, s33, v39
  v_pk_add_f32 v[54:55], v[54:55], v[62:63]
  s_waitcnt lgkmcnt(1)
  v_lshlrev_b32 v56, 16, v40
  v_and_b32_e64 v57, s33, v40
  v_pk_add_f32 v[48:49], v[48:49], v[56:57]
  v_lshlrev_b32 v58, 16, v41
  v_and_b32 v59, s33, v41
  v_pk_add_f32 v[50:51], v[50:51], v[58:59]
  v_lshlrev_b32 v60, 16, v42
  v_and_b32 v61, s33, v42
  v_pk_add_f32 v[52:53], v[52:53], v[60:61]
  v_lshlrev_b32 v62, 16, v43
  v_and_b32 v63, s33, v43
  v_pk_add_f32 v[54:55], v[54:55], v[62:63]
  s_waitcnt lgkmcnt(0)
  v_lshlrev_b32 v56, 16, v44
  v_and_b32_e64 v57, s33, v44
  v_pk_add_f32 v[48:49], v[48:49], v[56:57]
  v_lshlrev_b32 v58, 16, v45
  v_and_b32 v59, s33, v45
  v_pk_add_f32 v[50:51], v[50:51], v[58:59]
  v_lshlrev_b32 v60, 16, v46
  v_and_b32 v61, s33, v46
  v_pk_add_f32 v[52:53], v[52:53], v[60:61]
  v_lshlrev_b32 v62, 16, v47
  v_and_b32 v63, s33, v47
  v_pk_add_f32 v[54:55], v[54:55], v[62:63]
  s_nop 1
  v_permlane32_swap_b32 v48, v52
  v_permlane32_swap_b32 v49, v53
  v_permlane32_swap_b32 v50, v54
  v_permlane32_swap_b32 v51, v55
  v_add_f32 v48, v48, v52
  v_add_f32 v49, v49, v53
  v_add_f32 v50, v50, v54
  v_add_f32 v51, v51, v55
  s_nop 1
  v_permlane16_swap_b32 v48, v50
  v_permlane16_swap_b32 v49, v51
  v_add_f32_e64 v48, v48, v50
  v_add_f32 v49, v49, v51
  s_nop 1
  v_add_f32_dpp v48, v48, v48 row_ror:8 row_mask:0xf bank_mask:0xf
  v_add_f32_dpp v49, v49, v49 row_ror:8 row_mask:0xf bank_mask:0xf
  s_mov_b32 exec_lo, 0x007f007f
  s_mov_b32 exec_hi, 0x007f007f
  buffer_store_dwordx2 v[48:49], v12, s[44:47], s25 offen sc1
  s_mov_b64 exec, -1
  v_lshrrev_b32 v2, 4, v1
  v_bfe_u32 v3, v1, 2, 2
  v_and_b32 v4, 3, v1
  v_and_b32 v5, 1, v2
  v_lshlrev_b32_e64 v8, 4, v1
  s_mul_i32 s27, s18, 22528
  s_cmp_lt_u32 s17, 2
  s_cbranch_scc1 A_XL
  s_add_u32 s27, s27, 8192
  s_add_u32 s28, s27, 45056
  s_add_u32 s29, s27, 135168
  v_mov_b32 v20, 162848
A_WF:
  ds_read_b32 v24, v20
  s_waitcnt lgkmcnt(0)
  v_readfirstlane_b32 s20, v24
  s_nop 0
  s_cmp_ge_u32 s20, 4
  s_cbranch_scc1 A_WF_GO
  s_sleep 2
  s_branch A_WF
A_WF_GO:
  s_mul_i32 s24, s52, 458752
  s_mov_b32 m0, s28
  s_add_u32 s25, s24, 114688
  buffer_load_dwordx4 v96, s[36:39], s24 offen lds
  s_add_u32 m0, m0, 1024
  s_nop 0
  buffer_load_dwordx4 v97, s[36:39], s24 offen lds
  s_add_u32 m0, m0, 1024
  s_nop 0
  buffer_load_dwordx4 v98, s[36:39], s24 offen lds
  s_add_u32 m0, m0, 1024
  s_nop 0
  buffer_load_dwordx4 v99, s[36:39], s24 offen lds
  s_add_u32 m0, m0, 1024
  s_nop 0
  buffer_load_dwordx4 v100, s[36:39], s24 offen lds
  s_add_u32 m0, m0, 1024
  s_nop 0
  buffer_load_dwordx4 v101, s[36:39], s24 offen lds
  s_add_u32 m0, m0, 1024
  s_nop 0
  buffer_load_dwordx4 v102, s[36:39], s24 offen lds
  s_add_u32 m0, m0, 1024
  s_nop 0
  buffer_load_dwordx4 v96, s[36:39], s25 offen lds
  s_add_u32 m0, m0, 1024
  s_nop 0
  buffer_load_dwordx4 v97, s[36:39], s25 offen lds
  s_add_u32 m0, m0, 1024
  s_nop 0
  buffer_load_dwordx4 v98, s[36:39], s25 offen lds
  s_add_u32 m0, m0, 1024
  s_nop 0
  buffer_load_dwordx4 v99, s[36:39], s25 offen lds
  s_add_u32 s52, s52, 1
  s_and_b32 s52, s52, 15
  s_cmp_eq_u32 s52, s14
  s_addc_u32 s52, s52, 0
  s_and_b32 s52, s52, 15
  s_add_u32 s28, s28, 45056
  s_cmp_ge_u32 s28, s29
  s_cselect_b32 s28, s27, s28
  s_mov_b32 s32, 0
A_WLOOP:
  s_sub_u32 s21, s32, 2
  s_cmp_lt_u32 s21, 6
  s_cbranch_scc0 A_WW_A
  s_waitcnt vmcnt(13)
  s_branch A_WW_B
A_WW_A:
  s_waitcnt vmcnt(11)
A_WW_B:
  s_barrier
  s_mul_i32 s24, s52, 458752
  s_mov_b32 m0, s28
  s_add_u32 s25, s24, 114688
  buffer_load_dwordx4 v96, s[36:39], s24 offen lds
  s_add_u32 m0, m0, 1024
  s_nop 0
  buffer_load_dwordx4 v97, s[36:39], s24 offen lds
  s_add_u32 m0, m0, 1024
  s_nop 0
  buffer_load_dwordx4 v98, s[36:39], s24 offen lds
  s_add_u32 m0, m0, 1024
  s_nop 0
  buffer_load_dwordx4 v99, s[36:39], s24 offen lds
  s_add_u32 m0, m0, 1024
  s_nop 0
  buffer_load_dwordx4 v100, s[36:39], s24 offen lds
  s_add_u32 m0, m0, 1024
  s_nop 0
  buffer_load_dwordx4 v101, s[36:39], s24 offen lds
  s_add_u32 m0, m0, 1024
  s_nop 0
  buffer_load_dwordx4 v102, s[36:39], s24 offen lds
  s_add_u32 m0, m0, 1024
  s_nop 0
  buffer_load_dwordx4 v96, s[36:39], s25 offen lds
  s_add_u32 m0, m0, 1024
  s_nop 0
  buffer_load_dwordx4 v97, s[36:39], s25 offen lds
  s_add_u32 m0, m0, 1024
  s_nop 0
  buffer_load_dwordx4 v98, s[36:39], s25 offen lds
  s_add_u32 m0, m0, 1024
  s_nop 0
  buffer_load_dwordx4 v99, s[36:39], s25 offen lds
  s_add_u32 s52, s52, 1
  s_and_b32 s52, s52, 15
  s_cmp_eq_u32 s52, s14
  s_addc_u32 s52, s52, 0
  s_and_b32 s52, s52, 15
  s_add_u32 s28, s28, 45056
  s_cmp_ge_u32 s28, s29
  s_cselect_b32 s28, s27, s28
  s_cmp_lt_u32 s32, 7
  s_cbranch_scc0 A_WA_E
A_WA_0:
  s_cmp_eq_u32 s32, 0
  s_cbranch_scc0 A_WA_1
  buffer_store_dwordx4 v[112:115], v171, s[44:47], s94 offen sc1
  s_branch A_WA_E
A_WA_1:
  s_cmp_eq_u32 s32, 1
  s_cbranch_scc0 A_WA_2
  buffer_store_dwordx4 v[116:119], v172, s[44:47], s95 offen sc1
  s_branch A_WA_E
A_WA_2:
  s_cmp_eq_u32 s32, 2
  s_cbranch_scc0 A_WA_3
  buffer_store_dwordx4 v[120:123], v173, s[44:47], s96 offen sc1
  s_branch A_WA_E
A_WA_3:
  s_cmp_eq_u32 s32, 3
  s_cbranch_scc0 A_WA_4
  buffer_store_dwordx4 v[124:127], v174, s[44:47], s97 offen sc1
  s_branch A_WA_E
A_WA_4:
  s_cmp_eq_u32 s32, 4
  s_cbranch_scc0 A_WA_5
  buffer_store_dwordx4 v[128:131], v175, s[44:47], s98 offen sc1
  s_branch A_WA_E
A_WA_5:
  s_cmp_eq_u32 s32, 5
  s_cbranch_scc0 A_WA_6
  buffer_store_dwordx4 v[132:135], v176, s[44:47], s99 offen sc1
  s_branch A_WA_E
A_WA_6:
  buffer_store_dwordx4 v[136:139], v177, s[44:47], s100 offen sc1
A_WA_E:
  s_sub_u32 s55, s32, s53
  s_cmp_lt_u32 s55, 4
  s_cbranch_scc0 A_WS_E
  s_swappc_b64 s[58:59], s[60:61]
A_WS_E:
  s_add_u32 s32, s32, 1
  s_cmp_lt_u32 s32, 14
  s_cbranch_scc1 A_WLOOP
  s_waitcnt vmcnt(11)
  s_barrier
  s_branch A_LTAIL
A_XL:
  s_lshl_b32 s26, s14, 18
  s_lshl_b32 s21, s18, 13
  s_add_u32 s26, s26, s21
  s_add_u32 s26, s26, 0xc00000
  s_mov_b32 s28, s27
  s_add_u32 s29, s27, 135168
  s_lshl_b32 s21, s14, 8
  s_add_u32 s21, s21, 0x980000
  v_mov_b32 v22, s21
  v_mov_b32 v23, 1
  s_and_b32 s21, s2, 15
  s_lshl_b32 s21, s21, 8
  s_add_u32 s21, s21, 0x989000
  v_mov_b32 v17, s21
  s_add_u32 s54, s53, 6
  s_cmp_eq_u32 s17, 0
  s_cselect_b32 s54, s54, 10
  s_cbranch_scc1 A_X0
  v_mov_b32 v22, v17
A_X0:
  s_and_b32 s21, s2, 7
  s_lshl_b32 s21, s21, 12
  s_add_u32 s21, s21, 0x98a000
  v_add_u32_e64 v9, s21, v8
  v_mov_b32 v11, 162848
  s_cmp_eq_u32 s17, 0
  s_cbranch_scc0 A_X1
A_XF:
  ds_read_b32 v10, v11
  s_waitcnt lgkmcnt(0)
  v_readfirstlane_b32 s20, v10
  s_nop 0
  s_cmp_ge_u32 s20, 4
  s_cbranch_scc1 A_XF_GO
  s_sleep 2
  s_branch A_XF
A_XF_GO:
  s_mov_b32 s23, 0
A_XP:
  buffer_load_dword v12, v9, s[44:47], 0 offen offset:0 sc1
  buffer_load_dword v13, v9, s[44:47], 0 offen offset:1024 sc1
  buffer_load_dword v14, v9, s[44:47], 0 offen offset:2048 sc1
  buffer_load_dword v15, v9, s[44:47], 0 offen offset:3072 sc1
  s_waitcnt vmcnt(0)
  v_and_b32 v12, v12, v13
  v_bitop3_b32 v12, v12, v14, v15 bitop3:0x80
  v_cmp_eq_u32 vcc, 0, v12
  s_add_u32 s23, s23, 1
  s_cmp_ge_u32 s23, 0x200000
  s_cbranch_scc1 A_XP_GOT
  s_cmp_eq_u64 vcc, 0
  s_cbranch_scc1 A_XP_GOT
  s_sleep 4
  s_branch A_XP
A_XP_GOT:
  s_mov_b64 exec, -1
  ds_write_b32 v11, v23 offset:4
  s_cmp_eq_u32 s2, 0
  s_cbranch_scc0 A_X2
  s_load_dwordx2 s[20:21], s[0:1], 80
  v_mov_b32 v12, 0
  v_mov_b32 v13, 0
  s_waitcnt lgkmcnt(0)
  s_mov_b64 exec, 1
  global_store_dwordx2 v12, v[12:13], s[20:21] sc1
  s_mov_b64 exec, -1
  s_branch A_X2
A_X1:
  v_add_u32_e64 v11, 4, v11
A_XG:
  ds_read_b32 v10, v11
  s_waitcnt lgkmcnt(0)
  v_readfirstlane_b32 s20, v10
  s_nop 0
  s_cmp_ge_u32 s20, 1
  s_cbranch_scc1 A_XG_GO
  s_sleep 2
  s_branch A_XG
A_XG_GO:
A_X2:
  s_lshl_b32 s24, s14, 14
  s_mov_b32 m0, s28
  s_add_u32 s24, s24, s26
  buffer_load_dwordx4 v8, s[44:47], s24 offen offset:0 sc1 lds
  buffer_load_dwordx4 v8, s[44:47], s24 offen offset:1024 sc1 lds
  buffer_load_dwordx4 v8, s[44:47], s24 offen offset:2048 sc1 lds
  buffer_load_dwordx4 v8, s[44:47], s24 offen offset:3072 sc1 lds
  s_add_u32 m0, m0, 4096
  s_add_u32 s24, s24, 4096
  buffer_load_dwordx4 v8, s[44:47], s24 offen offset:0 sc1 lds
  buffer_load_dwordx4 v8, s[44:47], s24 offen offset:1024 sc1 lds
  buffer_load_dwordx4 v8, s[44:47], s24 offen offset:2048 sc1 lds
  buffer_load_dwordx4 v8, s[44:47], s24 offen offset:3072 sc1 lds
  s_add_u32 s28, s28, 45056
  s_cmp_ge_u32 s28, s29
  s_cselect_b32 s28, s27, s28
  s_lshl_b32 s24, s52, 14
  s_mov_b32 m0, s28
  s_add_u32 s24, s24, s26
  buffer_load_dwordx4 v8, s[44:47], s24 offen offset:0 sc1 lds
  buffer_load_dwordx4 v8, s[44:47], s24 offen offset:1024 sc1 lds
  buffer_load_dwordx4 v8, s[44:47], s24 offen offset:2048 sc1 lds
  buffer_load_dwordx4 v8, s[44:47], s24 offen offset:3072 sc1 lds
  s_add_u32 m0, m0, 4096
  s_add_u32 s24, s24, 4096
  buffer_load_dwordx4 v8, s[44:47], s24 offen offset:0 sc1 lds
  buffer_load_dwordx4 v8, s[44:47], s24 offen offset:1024 sc1 lds
  buffer_load_dwordx4 v8, s[44:47], s24 offen offset:2048 sc1 lds
  buffer_load_dwordx4 v8, s[44:47], s24 offen offset:3072 sc1 lds
  s_mul_i32 s25, s52, 458752
  s_add_u32 m0, s28, 19456
  s_add_u32 s25, s25, 114688
  buffer_load_dwordx4 v100, s[36:39], s25 offen lds
  s_add_u32 m0, m0, 1024
  s_nop 0
  buffer_load_dwordx4 v101, s[36:39], s25 offen lds
  s_add_u32 m0, m0, 1024
  s_nop 0
  buffer_load_dwordx4 v102, s[36:39], s25 offen lds
  s_add_u32 s52, s52, 1
  s_and_b32 s52, s52, 15
  s_cmp_eq_u32 s52, s14
  s_addc_u32 s52, s52, 0
  s_and_b32 s52, s52, 15
  s_add_u32 s28, s28, 45056
  s_cmp_ge_u32 s28, s29
  s_cselect_b32 s28, s27, s28
  s_mov_b32 s32, 0
A_XLOOP:
  s_sub_u32 s21, s32, 2
  s_cmp_lt_u32 s21, 6
  s_cbranch_scc0 A_XW_A
  s_waitcnt vmcnt(13)
  s_branch A_XW_B
A_XW_A:
  s_waitcnt vmcnt(11)
A_XW_B:
  s_barrier
  s_cmp_eq_u32 s32, s54
  s_cbranch_scc0 A_NOSIG
  s_mov_b64 exec, 1
  buffer_atomic_add v23, v22, s[44:47], 0 offen
  s_mov_b64 exec, -1
A_NOSIG:
  s_sub_u32 s55, s32, s53
  s_cmp_lt_u32 s55, 4
  s_cbranch_scc0 A_XS_E
  s_swappc_b64 s[58:59], s[60:61]
A_XS_E:
  s_lshl_b32 s24, s52, 14
  s_mov_b32 m0, s28
  s_add_u32 s24, s24, s26
  buffer_load_dwordx4 v8, s[44:47], s24 offen offset:0 sc1 lds
  buffer_load_dwordx4 v8, s[44:47], s24 offen offset:1024 sc1 lds
  buffer_load_dwordx4 v8, s[44:47], s24 offen offset:2048 sc1 lds
  buffer_load_dwordx4 v8, s[44:47], s24 offen offset:3072 sc1 lds
  s_add_u32 m0, m0, 4096
  s_add_u32 s24, s24, 4096
  buffer_load_dwordx4 v8, s[44:47], s24 offen offset:0 sc1 lds
  buffer_load_dwordx4 v8, s[44:47], s24 offen offset:1024 sc1 lds
  buffer_load_dwordx4 v8, s[44:47], s24 offen offset:2048 sc1 lds
  buffer_load_dwordx4 v8, s[44:47], s24 offen offset:3072 sc1 lds
  s_mul_i32 s25, s52, 458752
  s_add_u32 m0, s28, 19456
  s_add_u32 s25, s25, 114688
  buffer_load_dwordx4 v100, s[36:39], s25 offen lds
  s_add_u32 m0, m0, 1024
  s_nop 0
  buffer_load_dwordx4 v101, s[36:39], s25 offen lds
  s_add_u32 m0, m0, 1024
  s_nop 0
  buffer_load_dwordx4 v102, s[36:39], s25 offen lds
  s_add_u32 s52, s52, 1
  s_and_b32 s52, s52, 15
  s_cmp_eq_u32 s52, s14
  s_addc_u32 s52, s52, 0
  s_and_b32 s52, s52, 15
  s_add_u32 s28, s28, 45056
  s_cmp_ge_u32 s28, s29
  s_cselect_b32 s28, s27, s28
  s_cmp_lt_u32 s32, 7
  s_cbranch_scc0 A_XA_E
A_XA_0:
  s_cmp_eq_u32 s32, 0
  s_cbranch_scc0 A_XA_1
  buffer_store_dwordx4 v[112:115], v171, s[44:47], s94 offen sc1
  s_branch A_XA_E
A_XA_1:
  s_cmp_eq_u32 s32, 1
  s_cbranch_scc0 A_XA_2
  buffer_store_dwordx4 v[116:119], v172, s[44:47], s95 offen sc1
  s_branch A_XA_E
A_XA_2:
  s_cmp_eq_u32 s32, 2
  s_cbranch_scc0 A_XA_3
  buffer_store_dwordx4 v[120:123], v173, s[44:47], s96 offen sc1
  s_branch A_XA_E
A_XA_3:
  s_cmp_eq_u32 s32, 3
  s_cbranch_scc0 A_XA_4
  buffer_store_dwordx4 v[124:127], v174, s[44:47], s97 offen sc1
  s_branch A_XA_E
A_XA_4:
  s_cmp_eq_u32 s32, 4
  s_cbranch_scc0 A_XA_5
  buffer_store_dwordx4 v[128:131], v175, s[44:47], s98 offen sc1
  s_branch A_XA_E
A_XA_5:
  s_cmp_eq_u32 s32, 5
  s_cbranch_scc0 A_XA_6
  buffer_store_dwordx4 v[132:135], v176, s[44:47], s99 offen sc1
  s_branch A_XA_E
A_XA_6:
  buffer_store_dwordx4 v[136:139], v177, s[44:47], s100 offen sc1
A_XA_E:
  s_add_u32 s32, s32, 1
  s_cmp_lt_u32 s32, 14
  s_cbranch_scc1 A_XLOOP
  s_waitcnt vmcnt(11)
  s_barrier
A_LTAIL:
  v_lshlrev_b32 v7, 8, v1
  v_add_u32 v7, 0x989000, v7
  s_lshl_b32 s21, s14, 8
  s_add_u32 s21, s21, 0x980000
  v_mov_b32 v6, s21
  v_cmp_eq_u32 vcc, 16, v1
  s_nop 1
  v_cndmask_b32 v7, v7, v6, vcc
  s_mov_b32 s23, 0
  s_mov_b64 exec, 0x1ffff
A_SP:
  buffer_load_dword v21, v7, s[44:47], 0 offen sc1
  s_waitcnt vmcnt(0)
  v_cmp_gt_u32 vcc, 16, v21
  s_add_u32 s23, s23, 1
  s_cmp_ge_u32 s23, 0x200000
  s_cbranch_scc1 A_SP_GOT
  s_cmp_eq_u64 vcc, 0
  s_cbranch_scc1 A_SP_GOT
  s_sleep 3
  s_branch A_SP
A_SP_GOT:
  s_mov_b64 exec, -1
  s_lshl_b32 s21, s14, 2
  s_add_u32 s21, s21, s17
  s_lshl_b32 s21, s21, 12
  s_add_u32 s21, s21, 0x9c0000
  v_lshlrev_b32_e64 v6, 2, v1
  buffer_load_dword v40, v6, s[44:47], s21 offen offset:0 sc1
  buffer_load_dword v41, v6, s[44:47], s21 offen offset:256 sc1
  buffer_load_dword v42, v6, s[44:47], s21 offen offset:512 sc1
  buffer_load_dword v43, v6, s[44:47], s21 offen offset:768 sc1
  buffer_load_dword v44, v6, s[44:47], s21 offen offset:1024 sc1
  buffer_load_dword v45, v6, s[44:47], s21 offen offset:1280 sc1
  buffer_load_dword v46, v6, s[44:47], s21 offen offset:1536 sc1
  buffer_load_dword v47, v6, s[44:47], s21 offen offset:1792 sc1
  buffer_load_dword v48, v6, s[44:47], s21 offen offset:2048 sc1
  buffer_load_dword v49, v6, s[44:47], s21 offen offset:2304 sc1
  buffer_load_dword v50, v6, s[44:47], s21 offen offset:2560 sc1
  buffer_load_dword v51, v6, s[44:47], s21 offen offset:2816 sc1
  buffer_load_dword v52, v6, s[44:47], s21 offen offset:3072 sc1
  buffer_load_dword v53, v6, s[44:47], s21 offen offset:3328 sc1
  buffer_load_dword v54, v6, s[44:47], s21 offen offset:3584 sc1
  buffer_load_dword v55, v6, s[44:47], s21 offen offset:3840 sc1
  s_mul_i32 s21, s15, 896
  s_mul_i32 s22, s17, 224
  s_add_u32 s21, s21, s22
  s_add_u32 s21, s21, 0x900000
  buffer_load_dword v24, v6, s[44:47], s21 offen sc1
  s_add_u32 s21, s21, 14336
  buffer_load_dword v25, v6, s[44:47], s21 offen sc1
  s_add_u32 s21, s21, 14336
  buffer_load_dword v26, v6, s[44:47], s21 offen sc1
  s_add_u32 s21, s21, 14336
  buffer_load_dword v27, v6, s[44:47], s21 offen sc1
  s_add_u32 s21, s21, 14336
  buffer_load_dword v28, v6, s[44:47], s21 offen sc1
  s_add_u32 s21, s21, 14336
  buffer_load_dword v29, v6, s[44:47], s21 offen sc1
  s_add_u32 s21, s21, 14336
  buffer_load_dword v30, v6, s[44:47], s21 offen sc1
  s_add_u32 s21, s21, 14336
  buffer_load_dword v31, v6, s[44:47], s21 offen sc1
  s_add_u32 s21, s21, 14336
  buffer_load_dword v32, v6, s[44:47], s21 offen sc1
  s_add_u32 s21, s21, 14336
  buffer_load_dword v33, v6, s[44:47], s21 offen sc1
  s_add_u32 s21, s21, 14336
  buffer_load_dword v34, v6, s[44:47], s21 offen sc1
  s_add_u32 s21, s21, 14336
  buffer_load_dword v35, v6, s[44:47], s21 offen sc1
  s_add_u32 s21, s21, 14336
  buffer_load_dword v36, v6, s[44:47], s21 offen sc1
  s_add_u32 s21, s21, 14336
  buffer_load_dword v37, v6, s[44:47], s21 offen sc1
  s_add_u32 s21, s21, 14336
  buffer_load_dword v38, v6, s[44:47], s21 offen sc1
  s_add_u32 s21, s21, 14336
  buffer_load_dword v39, v6, s[44:47], s21 offen sc1
  s_add_u32 s21, s21, 14336
  s_barrier
  s_mul_i32 s22, s17, 224
  s_add_u32 s22, s22, 149504
  v_add_u32 v6, s22, v6
  v_lshlrev_b32 v22, 3, v3
  v_add_u32 v22, v22, v4
  v_lshlrev_b32 v23, 2, v5
  v_add_u32_e64 v22, v22, v23
  v_lshlrev_b32 v22, 4, v22
  s_lshl_b32 s22, s17, 9
  s_add_u32 s22, s22, 147456
  v_add_u32 v22, s22, v22
  s_waitcnt vmcnt(16)
  v_add_f32 v40, v40, v48
  v_add_f32 v41, v41, v49
  v_add_f32 v42, v42, v50
  v_add_f32 v43, v43, v51
  v_add_f32 v44, v44, v52
  v_add_f32 v45, v45, v53
  v_add_f32 v46, v46, v54
  v_add_f32 v47, v47, v55
  v_add_f32 v40, v40, v44
  v_add_f32 v41, v41, v45
  v_add_f32 v42, v42, v46
  v_add_f32 v43, v43, v47
  v_add_f32 v40, v40, v42
  v_add_f32 v41, v41, v43
  v_add_f32 v40, v40, v41
  v_mov_b32 v41, v40
  s_nop 1
  v_permlane32_swap_b32 v40, v41
  v_mul_f32 v40, 0x3a800000, v40
  v_mul_f32 v41, 0x3a800000, v41
  v_fma_f32 v41, -v40, v40, v41
  v_max_f32_e64 v41, 0, v41
  v_cvt_pk_bf16_f32 v42, v41, v41
  v_lshlrev_b32_e64 v42, 16, v42
  v_add_f32 v42, 0x3727c5ac, v42
  v_cvt_pk_bf16_f32 v42, v42, v42
  v_lshlrev_b32_e64 v42, 16, v42
  v_sqrt_f32 v42, v42
  s_nop 0
  v_cvt_pk_bf16_f32 v40, v40, v42
  v_and_b32 v46, 0xffff0000, v40
  v_rcp_f32 v45, v46
  v_lshlrev_b32 v44, 16, v40
  v_xor_b32 v44, 0x80000000, v44
  v_mov_b32_e64 v47, v46
  v_mul_f32 v45, 0xbfb8aa3b, v45
  ds_write_b128 v22, v[44:47]
  s_waitcnt vmcnt(0)
  v_add_f32 v24, v24, v32
  v_add_f32 v25, v25, v33
  v_add_f32 v26, v26, v34
  v_add_f32 v27, v27, v35
  v_add_f32 v28, v28, v36
  v_add_f32 v29, v29, v37
  v_add_f32 v30, v30, v38
  v_add_f32 v31, v31, v39
  v_add_f32 v24, v24, v28
  v_add_f32 v25, v25, v29
  v_add_f32 v26, v26, v30
  v_add_f32 v27, v27, v31
  v_add_f32 v24, v24, v26
  v_add_f32 v25, v25, v27
  v_add_f32 v24, v24, v25
  s_mov_b32 exec_hi, 0x00ffffff
  ds_write_b32 v6, v24
  s_mov_b64 exec, -1
  s_lshl_b32 s21, s14, 1
  s_lshr_b32 s22, s15, 3
  s_add_u32 s21, s21, s22
  s_lshl_b32 s21, s21, 10
  s_and_b32 s22, s15, 7
  s_lshl_b32 s22, s22, 4
  s_add_u32 s21, s21, s22
  s_add_u32 s21, s21, 0x981100
  v_lshlrev_b32 v12, 2, v1
  v_add_u32 v12, s21, v12
  v_mov_b32_e64 v13, 1
  s_lshr_b32 s19, s15, 3
  s_and_b32 s15, s15, 7
  s_mov_b32 s30, 32768
  s_mov_b32 s31, 4294868992
  s_lshr_b32 s18, s17, 1
  s_and_b32 s20, s17, 1
  s_mul_i32 s21, s14, 112
  s_mul_i32 s22, s19, 56
  s_add_u32 s22, s22, s18
  s_add_u32 s21, s21, s22
  s_mul_i32 s21, s21, 10240
  s_add_u32 s21, s21, 0x1000000
  s_mul_i32 s23, s15, 112
  s_add_u32 s23, s23, s22
  s_mul_i32 s23, s23, 10240
  s_add_u32 s23, s23, 0x3000000
  v_lshrrev_b32 v14, 3, v1
  v_add_u32 v14, 0, v14
  v_add_u32 v15, 4, v14
  v_mul_u32_u24 v15, 37, v15
  v_lshrrev_b32_e64 v15, 8, v15
  v_add_lshl_u32 v24, v14, v15, 7
  v_and_b32_e64 v14, 7, v1
  v_lshl_add_u32 v24, v14, 4, v24
  v_lshrrev_b32 v14, 3, v1
  v_add_u32 v14, 8, v14
  v_add_u32 v15, 4, v14
  v_mul_u32_u24 v15, 37, v15
  v_lshrrev_b32_e64 v15, 8, v15
  v_add_lshl_u32 v25, v14, v15, 7
  v_and_b32_e64 v14, 7, v1
  v_lshl_add_u32 v25, v14, 4, v25
  v_lshrrev_b32 v14, 3, v1
  v_add_u32 v14, 16, v14
  v_add_u32 v15, 4, v14
  v_mul_u32_u24 v15, 37, v15
  v_lshrrev_b32_e64 v15, 8, v15
  v_add_lshl_u32 v26, v14, v15, 7
  v_and_b32_e64 v14, 7, v1
  v_lshl_add_u32 v26, v14, 4, v26
  v_lshrrev_b32 v14, 3, v1
  v_add_u32 v14, 24, v14
  v_add_u32 v15, 4, v14
  v_mul_u32_u24 v15, 37, v15
  v_lshrrev_b32_e64 v15, 8, v15
  v_add_lshl_u32 v27, v14, v15, 7
  v_and_b32_e64 v14, 7, v1
  v_lshl_add_u32 v27, v14, 4, v27
  v_lshrrev_b32 v14, 3, v1
  v_add_u32 v14, 32, v14
  v_add_u32 v15, 4, v14
  v_mul_u32_u24 v15, 37, v15
  v_lshrrev_b32_e64 v15, 8, v15
  v_add_lshl_u32 v28, v14, v15, 7
  v_and_b32_e64 v14, 7, v1
  v_lshl_add_u32 v28, v14, 4, v28
  v_lshrrev_b32 v14, 3, v1
  v_add_u32 v14, 40, v14
  v_add_u32 v15, 4, v14
  v_mul_u32_u24 v15, 37, v15
  v_lshrrev_b32_e64 v15, 8, v15
  v_add_lshl_u32 v29, v14, v15, 7
  v_and_b32_e64 v14, 7, v1
  v_lshl_add_u32 v29, v14, 4, v29
  v_lshrrev_b32 v14, 3, v1
  v_add_u32 v14, 48, v14
  v_add_u32 v15, 4, v14
  v_mul_u32_u24 v15, 37, v15
  v_lshrrev_b32_e64 v15, 8, v15
  v_add_lshl_u32 v30, v14, v15, 7
  v_and_b32_e64 v14, 7, v1
  v_lshl_add_u32 v30, v14, 4, v30
  v_lshrrev_b32 v14, 3, v1
  v_add_u32 v14, 56, v14
  v_add_u32 v15, 4, v14
  v_mul_u32_u24 v15, 37, v15
  v_lshrrev_b32_e64 v15, 8, v15
  v_add_lshl_u32 v31, v14, v15, 7
  v_and_b32_e64 v14, 7, v1
  v_lshl_add_u32 v31, v14, 4, v31
  s_cmp_eq_u32 s20, 0
  s_cselect_b32 s26, s21, s23
  s_cselect_b32 s39, 3, 99
  s_mov_b32 s38, 3
  s_mov_b32 s54, 0x010101
  s_lshl_b32 s54, s54, s15
  s_xor_b32 s54, s54, 0x0fffffff
  s_lshl_b32 s21, s15, 7
  s_lshl_b32 s22, s19, 6
  s_add_u32 s21, s21, s22
  s_lshl_b32 s22, s17, 4
  s_add_u32 s21, s21, s22
  s_lshl_b32 s21, s21, 8
  s_lshl_b32 s22, s14, 18
  s_add_u32 s21, s21, s22
  s_add_u32 s41, s21, 0xc00000
  s_lshl_b32 s27, s17, 13
  s_add_u32 s28, s27, 65536
  s_add_u32 s29, s27, 131072
  s_lshl_b32 s21, s14, 1
  s_add_u32 s21, s21, s19
  s_lshl_b32 s21, s21, 10
  s_add_u32 s21, s21, 0x981000
  v_lshlrev_b32_e64 v9, 2, v1
  v_add_u32 v9, s21, v9
  s_lshl_b32 s21, s17, 12
  s_add_u32 m0, s21, 131072
  s_nop 0
  buffer_load_dwordx4 v8, s[44:47], s41 offen offset:0 sc1 lds
  buffer_load_dwordx4 v8, s[44:47], s41 offen offset:1024 sc1 lds
  buffer_load_dwordx4 v8, s[44:47], s41 offen offset:2048 sc1 lds
  buffer_load_dwordx4 v8, s[44:47], s41 offen offset:3072 sc1 lds
  s_cmp_eq_u32 s20, 0
  s_cbranch_scc1 B_HFIRST
  s_add_u32 s24, s15, 0
  s_mul_i32 s24, s24, 20480
  s_add_u32 s24, s24, s26
  s_mov_b32 m0, s28
  s_nop 0
  buffer_load_dwordx4 v24, s[44:47], s24 offen sc1 lds
  s_add_u32 m0, m0, 1024
  s_nop 0
  buffer_load_dwordx4 v25, s[44:47], s24 offen sc1 lds
  s_add_u32 m0, m0, 1024
  s_nop 0
  buffer_load_dwordx4 v26, s[44:47], s24 offen sc1 lds
  s_add_u32 m0, m0, 1024
  s_nop 0
  buffer_load_dwordx4 v27, s[44:47], s24 offen sc1 lds
  s_add_u32 m0, m0, 1024
  s_nop 0
  buffer_load_dwordx4 v28, s[44:47], s24 offen sc1 lds
  s_add_u32 m0, m0, 1024
  s_nop 0
  buffer_load_dwordx4 v29, s[44:47], s24 offen sc1 lds
  s_add_u32 m0, m0, 1024
  s_nop 0
  buffer_load_dwordx4 v30, s[44:47], s24 offen sc1 lds
  s_add_u32 m0, m0, 1024
  s_nop 0
  buffer_load_dwordx4 v31, s[44:47], s24 offen sc1 lds
  s_add_u32 s28, s28, 32768
  s_cmp_ge_u32 s28, s29
  s_cselect_b32 s28, s27, s28
  s_add_u32 s24, s15, 8
  s_mul_i32 s24, s24, 20480
  s_add_u32 s24, s24, s26
  s_mov_b32 m0, s28
  s_nop 0
  buffer_load_dwordx4 v24, s[44:47], s24 offen sc1 lds
  s_add_u32 m0, m0, 1024
  s_nop 0
  buffer_load_dwordx4 v25, s[44:47], s24 offen sc1 lds
  s_add_u32 m0, m0, 1024
  s_nop 0
  buffer_load_dwordx4 v26, s[44:47], s24 offen sc1 lds
  s_add_u32 m0, m0, 1024
  s_nop 0
  buffer_load_dwordx4 v27, s[44:47], s24 offen sc1 lds
  s_add_u32 m0, m0, 1024
  s_nop 0
  buffer_load_dwordx4 v28, s[44:47], s24 offen sc1 lds
  s_add_u32 m0, m0, 1024
  s_nop 0
  buffer_load_dwordx4 v29, s[44:47], s24 offen sc1 lds
  s_add_u32 m0, m0, 1024
  s_nop 0
  buffer_load_dwordx4 v30, s[44:47], s24 offen sc1 lds
  s_add_u32 m0, m0, 1024
  s_nop 0
  buffer_load_dwordx4 v31, s[44:47], s24 offen sc1 lds
  s_add_u32 s28, s28, 32768
  s_cmp_ge_u32 s28, s29
  s_cselect_b32 s28, s27, s28
  s_waitcnt lgkmcnt(0)
  s_barrier
  s_add_u32 s24, s15, 16
  s_mul_i32 s24, s24, 20480
  s_add_u32 s24, s24, s26
  s_mov_b32 m0, s28
  s_nop 0
  buffer_load_dwordx4 v24, s[44:47], s24 offen sc1 lds
  s_add_u32 m0, m0, 1024
  s_nop 0
  buffer_load_dwordx4 v25, s[44:47], s24 offen sc1 lds
  s_add_u32 m0, m0, 1024
  s_nop 0
  buffer_load_dwordx4 v26, s[44:47], s24 offen sc1 lds
  s_add_u32 m0, m0, 1024
  s_nop 0
  buffer_load_dwordx4 v27, s[44:47], s24 offen sc1 lds
  s_add_u32 m0, m0, 1024
  s_nop 0
  buffer_load_dwordx4 v28, s[44:47], s24 offen sc1 lds
  s_add_u32 m0, m0, 1024
  s_nop 0
  buffer_load_dwordx4 v29, s[44:47], s24 offen sc1 lds
  s_add_u32 m0, m0, 1024
  s_nop 0
  buffer_load_dwordx4 v30, s[44:47], s24 offen sc1 lds
  s_add_u32 m0, m0, 1024
  s_nop 0
  buffer_load_dwordx4 v31, s[44:47], s24 offen sc1 lds
  s_add_u32 s28, s28, 32768
  s_cmp_ge_u32 s28, s29
  s_cselect_b32 s28, s27, s28
  s_ff1_i32_b32 s24, s54
  s_bitset0_b32 s54, s24
  s_mul_i32 s24, s24, 20480
  s_add_u32 s24, s24, s26
  s_mov_b32 m0, s28
  s_nop 0
  buffer_load_dwordx4 v24, s[44:47], s24 offen sc1 lds
  s_add_u32 m0, m0, 1024
  s_nop 0
  buffer_load_dwordx4 v25, s[44:47], s24 offen sc1 lds
  s_add_u32 m0, m0, 1024
  s_nop 0
  buffer_load_dwordx4 v26, s[44:47], s24 offen sc1 lds
  s_add_u32 m0, m0, 1024
  s_nop 0
  buffer_load_dwordx4 v27, s[44:47], s24 offen sc1 lds
  s_add_u32 m0, m0, 1024
  s_nop 0
  buffer_load_dwordx4 v28, s[44:47], s24 offen sc1 lds
  s_add_u32 m0, m0, 1024
  s_nop 0
  buffer_load_dwordx4 v29, s[44:47], s24 offen sc1 lds
  s_add_u32 m0, m0, 1024
  s_nop 0
  buffer_load_dwordx4 v30, s[44:47], s24 offen sc1 lds
  s_add_u32 m0, m0, 1024
  s_nop 0
  buffer_load_dwordx4 v31, s[44:47], s24 offen sc1 lds
  s_add_u32 s28, s28, 32768
  s_cmp_ge_u32 s28, s29
  s_cselect_b32 s28, s27, s28
  s_add_u32 s38, s38, 1
  s_waitcnt vmcnt(16)
  s_barrier
  s_waitcnt vmcnt(8)
  s_branch B_FIRST
B_HFIRST:
  s_add_u32 s28, s27, 32768
  s_nop 0
  v_mov_b32 v14, 162860
  s_waitcnt lgkmcnt(0)
  s_barrier
B_CF:
  ds_read_b32 v10, v14
  s_waitcnt lgkmcnt(0)
  v_readfirstlane_b32 s20, v10
  s_nop 0
  s_cmp_ge_u32 s20, 4
  s_cbranch_scc1 B_CF_GO
  s_sleep 2
  s_branch B_CF
B_CF_GO:
  buffer_load_dword v11, v9, s[44:47], 0 offen sc1
  s_waitcnt vmcnt(0)
  v_cmp_eq_u32 vcc, 0, v11
  s_nop 1
  s_cmp_eq_u32 vcc_lo, 0
  s_cbranch_scc0 B_LATE
  v_add_u32 v9, 256, v9
  s_add_u32 s39, s39, 7
  s_cmp_eq_u32 s39, 17
  s_cselect_b32 s39, 99, s39
  s_ff1_i32_b32 s24, s54
  s_bitset0_b32 s54, s24
  s_mul_i32 s24, s24, 20480
  s_add_u32 s24, s24, s26
  s_mov_b32 m0, s28
  s_nop 0
  buffer_load_dwordx4 v24, s[44:47], s24 offen sc1 lds
  s_add_u32 m0, m0, 1024
  s_nop 0
  buffer_load_dwordx4 v25, s[44:47], s24 offen sc1 lds
  s_add_u32 m0, m0, 1024
  s_nop 0
  buffer_load_dwordx4 v26, s[44:47], s24 offen sc1 lds
  s_add_u32 m0, m0, 1024
  s_nop 0
  buffer_load_dwordx4 v27, s[44:47], s24 offen sc1 lds
  s_add_u32 m0, m0, 1024
  s_nop 0
  buffer_load_dwordx4 v28, s[44:47], s24 offen sc1 lds
  s_add_u32 m0, m0, 1024
  s_nop 0
  buffer_load_dwordx4 v29, s[44:47], s24 offen sc1 lds
  s_add_u32 m0, m0, 1024
  s_nop 0
  buffer_load_dwordx4 v30, s[44:47], s24 offen sc1 lds
  s_add_u32 m0, m0, 1024
  s_nop 0
  buffer_load_dwordx4 v31, s[44:47], s24 offen sc1 lds
  s_add_u32 s28, s28, 32768
  s_cmp_ge_u32 s28, s29
  s_cselect_b32 s28, s27, s28
  s_add_u32 s38, s38, 1
  s_barrier
  s_branch B_FIRST
B_LATE:
  s_barrier
  s_mov_b32 s23, 0
  s_mov_b32 exec_hi, 0
B_P0:
  buffer_load_dword v10, v9, s[44:47], 0 offen sc1
  s_waitcnt vmcnt(0)
  v_cmp_eq_u32 vcc, 0, v10
  s_add_u32 s23, s23, 1
  s_cmp_ge_u32 s23, 0x200000
  s_cbranch_scc1 B_P0_GOT
  s_cmp_eq_u64 vcc, 0
  s_cbranch_scc1 B_P0_GOT
  s_sleep 2
  s_branch B_P0
B_P0_GOT:
  s_mov_b64 exec, -1
  s_nop 0
  v_add_u32 v9, 256, v9
  s_add_u32 s39, s39, 7
  s_cmp_eq_u32 s39, 17
  s_cselect_b32 s39, 99, s39
  s_ff1_i32_b32 s24, s54
  s_bitset0_b32 s54, s24
  s_mul_i32 s24, s24, 20480
  s_add_u32 s24, s24, s26
  s_mov_b32 m0, s28
  s_nop 0
  buffer_load_dwordx4 v24, s[44:47], s24 offen sc1 lds
  s_add_u32 m0, m0, 1024
  s_nop 0
  buffer_load_dwordx4 v25, s[44:47], s24 offen sc1 lds
  s_add_u32 m0, m0, 1024
  s_nop 0
  buffer_load_dwordx4 v26, s[44:47], s24 offen sc1 lds
  s_add_u32 m0, m0, 1024
  s_nop 0
  buffer_load_dwordx4 v27, s[44:47], s24 offen sc1 lds
  s_add_u32 m0, m0, 1024
  s_nop 0
  buffer_load_dwordx4 v28, s[44:47], s24 offen sc1 lds
  s_add_u32 m0, m0, 1024
  s_nop 0
  buffer_load_dwordx4 v29, s[44:47], s24 offen sc1 lds
  s_add_u32 m0, m0, 1024
  s_nop 0
  buffer_load_dwordx4 v30, s[44:47], s24 offen sc1 lds
  s_add_u32 m0, m0, 1024
  s_nop 0
  buffer_load_dwordx4 v31, s[44:47], s24 offen sc1 lds
  s_add_u32 s28, s28, 32768
  s_cmp_ge_u32 s28, s29
  s_cselect_b32 s28, s27, s28
  s_add_u32 s38, s38, 1
B_FIRST:
  v_mov_b32 v11, 0
  s_barrier
  s_cmp_eq_u32 s17, 1
  s_cselect_b32 s40, 3, 99
  s_ff1_i32_b32 s24, s54
  s_bitset0_b32 s54, s24
  s_mul_i32 s24, s24, 20480
  s_add_u32 s24, s24, s26
  s_mov_b32 m0, s28
  s_nop 0
  buffer_load_dwordx4 v24, s[44:47], s24 offen sc1 lds
  s_add_u32 m0, m0, 1024
  s_nop 0
  buffer_load_dwordx4 v25, s[44:47], s24 offen sc1 lds
  s_add_u32 m0, m0, 1024
  s_nop 0
  buffer_load_dwordx4 v26, s[44:47], s24 offen sc1 lds
  s_add_u32 m0, m0, 1024
  s_nop 0
  buffer_load_dwordx4 v27, s[44:47], s24 offen sc1 lds
  s_add_u32 m0, m0, 1024
  s_nop 0
  buffer_load_dwordx4 v28, s[44:47], s24 offen sc1 lds
  s_add_u32 m0, m0, 1024
  s_nop 0
  buffer_load_dwordx4 v29, s[44:47], s24 offen sc1 lds
  s_add_u32 m0, m0, 1024
  s_nop 0
  buffer_load_dwordx4 v30, s[44:47], s24 offen sc1 lds
  s_add_u32 m0, m0, 1024
  s_nop 0
  buffer_load_dwordx4 v31, s[44:47], s24 offen sc1 lds
  s_add_u32 s28, s28, 32768
  s_cmp_ge_u32 s28, s29
  s_cselect_b32 s28, s27, s28
  s_add_u32 s38, s38, 1
  s_ff1_i32_b32 s24, s54
  s_bitset0_b32 s54, s24
  s_mul_i32 s24, s24, 20480
  s_add_u32 s24, s24, s26
  s_mov_b32 m0, s28
  s_nop 0
  buffer_load_dwordx4 v24, s[44:47], s24 offen sc1 lds
  s_add_u32 m0, m0, 1024
  s_nop 0
  buffer_load_dwordx4 v25, s[44:47], s24 offen sc1 lds
  s_add_u32 m0, m0, 1024
  s_nop 0
  buffer_load_dwordx4 v26, s[44:47], s24 offen sc1 lds
  s_add_u32 m0, m0, 1024
  s_nop 0
  buffer_load_dwordx4 v27, s[44:47], s24 offen sc1 lds
  s_add_u32 m0, m0, 1024
  s_nop 0
  buffer_load_dwordx4 v28, s[44:47], s24 offen sc1 lds
  s_add_u32 m0, m0, 1024
  s_nop 0
  buffer_load_dwordx4 v29, s[44:47], s24 offen sc1 lds
  s_add_u32 m0, m0, 1024
  s_nop 0
  buffer_load_dwordx4 v30, s[44:47], s24 offen sc1 lds
  s_add_u32 m0, m0, 1024
  s_nop 0
  buffer_load_dwordx4 v31, s[44:47], s24 offen sc1 lds
  s_add_u32 s28, s28, 32768
  s_cmp_ge_u32 s28, s29
  s_cselect_b32 s28, s27, s28
  s_add_u32 s38, s38, 1
  s_mov_b32 s32, 3
B_LLOOP:
  s_ff1_i32_b32 s24, s54
  s_bitset0_b32 s54, s24
  s_mul_i32 s24, s24, 20480
  s_add_u32 s24, s24, s26
  s_mov_b32 m0, s28
  s_waitcnt vmcnt(16)
  s_cmp_eq_u32 s38, s39
  s_cbranch_scc0 B_PL_DONE
  v_cmp_eq_u32 vcc, 0, v11
  s_nop 1
  s_cmp_eq_u32 vcc_lo, 0
  s_cbranch_scc1 B_PL_DONE
  s_mov_b32 s23, 0
  s_mov_b32 exec_hi, 0
B_PL:
  buffer_load_dword v10, v9, s[44:47], 0 offen sc1
  s_waitcnt vmcnt(0)
  v_cmp_eq_u32 vcc, 0, v10
  s_add_u32 s23, s23, 1
  s_cmp_ge_u32 s23, 0x200000
  s_cbranch_scc1 B_PL_GOT
  s_cmp_eq_u64 vcc, 0
  s_cbranch_scc1 B_PL_GOT
  s_sleep 2
  s_branch B_PL
B_PL_GOT:
  s_mov_b64 exec, -1
B_PL_DONE:
  s_barrier
  buffer_load_dwordx4 v24, s[44:47], s24 offen sc1 lds
  s_add_u32 m0, m0, 1024
  s_nop 0
  buffer_load_dwordx4 v25, s[44:47], s24 offen sc1 lds
  s_add_u32 m0, m0, 1024
  s_nop 0
  buffer_load_dwordx4 v26, s[44:47], s24 offen sc1 lds
  s_add_u32 m0, m0, 1024
  s_nop 0
  buffer_load_dwordx4 v27, s[44:47], s24 offen sc1 lds
  s_add_u32 m0, m0, 1024
  s_nop 0
  buffer_load_dwordx4 v28, s[44:47], s24 offen sc1 lds
  s_add_u32 m0, m0, 1024
  s_nop 0
  buffer_load_dwordx4 v29, s[44:47], s24 offen sc1 lds
  s_add_u32 m0, m0, 1024
  s_nop 0
  buffer_load_dwordx4 v30, s[44:47], s24 offen sc1 lds
  s_add_u32 m0, m0, 1024
  s_nop 0
  buffer_load_dwordx4 v31, s[44:47], s24 offen sc1 lds
  s_add_u32 s28, s28, 32768
  s_cmp_ge_u32 s28, s29
  s_cselect_b32 s28, s27, s28
  s_add_u32 s38, s38, 1
  s_cmp_eq_u32 s32, s40
  s_cbranch_scc0 B_NS2
  s_mov_b64 exec, 15
  buffer_store_dword v13, v12, s[44:47], 0 offen sc1
  s_mov_b64 exec, -1
B_NS2:
  s_add_u32 s21, s38, 2
  s_cmp_eq_u32 s21, s39
  s_cbranch_scc0 B_NOPRE
  buffer_load_dword v11, v9, s[44:47], 0 offen sc1
B_NOPRE:
  s_add_u32 s32, s32, 1
  s_cmp_lt_u32 s32, 25
  s_cbranch_scc1 B_LLOOP
  s_waitcnt vmcnt(16)
  s_barrier
  s_waitcnt vmcnt(8)
  s_barrier
  s_waitcnt vmcnt(0)
  s_barrier
  s_endpgm
MK_C:
  s_lshl_b32 s3, s2, 14
  v_lshlrev_b32 v9, 3, v0
  v_add_u32 v9, s3, v9
  v_add_u32 v2, 0xffffe800, v9
  v_add_u32 v3, 0xfffff800, v9
  v_lshlrev_b32_e64 v4, 5, v0
  s_mov_b32 s34, 4096
  s_mov_b32 s35, 8192
  s_mov_b32 s36, 12288
  s_waitcnt lgkmcnt(0)
  s_mov_b32 s52, s26
  s_and_b32 s53, s27, 0xffff
  s_mov_b32 s54, 0x400000
  s_mov_b32 s55, 0x00020000
  s_mov_b32 s60, s30
  s_and_b32 s61, s31, 0xffff
  s_mov_b32 s62, 0x2000
  s_mov_b32 s63, 0x00020000
  s_mov_b32 s56, s28
  s_and_b32 s57, s29, 0xffff
  s_mov_b32 s58, 0x400000
  s_mov_b32 s59, 0x00020000
  s_mov_b32 s48, s24
  s_and_b32 s49, s25, 0xffff
  s_mov_b32 s50, 0x400000
  s_mov_b32 s51, 0x00020000
  buffer_load_dwordx4 v[64:67], v4, s[60:63], 0 offen
  buffer_load_dwordx4 v[68:71], v4, s[60:63], 0 offen offset:16
  buffer_load_dwordx2 v[10:11], v2, s[52:55], 0 offen
  buffer_load_dwordx2 v[12:13], v2, s[52:55], 0 offen offset:2048
  buffer_load_dwordx2 v[14:15], v3, s[52:55], 0 offen
  buffer_load_dwordx2 v[16:17], v9, s[52:55], 0 offen offset:0
  buffer_load_dwordx2 v[18:19], v9, s[52:55], 0 offen offset:2048
  buffer_load_dwordx2 v[20:21], v9, s[52:55], s34 offen offset:0
  buffer_load_dwordx2 v[22:23], v9, s[52:55], s34 offen offset:2048
  buffer_load_dwordx2 v[24:25], v9, s[52:55], s35 offen offset:0
  buffer_load_dwordx2 v[26:27], v9, s[52:55], s35 offen offset:2048
  buffer_load_dwordx2 v[28:29], v9, s[52:55], s36 offen offset:0
  buffer_load_dwordx2 v[30:31], v9, s[52:55], s36 offen offset:2048
  buffer_load_dwordx2 v[32:33], v9, s[56:59], 0 offen offset:0
  buffer_load_dwordx2 v[34:35], v9, s[56:59], 0 offen offset:2048
  buffer_load_dwordx2 v[36:37], v9, s[56:59], s34 offen offset:0
  buffer_load_dwordx2 v[38:39], v9, s[56:59], s34 offen offset:2048
  buffer_load_dwordx2 v[40:41], v9, s[56:59], s35 offen offset:0
  buffer_load_dwordx2 v[42:43], v9, s[56:59], s35 offen offset:2048
  buffer_load_dwordx2 v[44:45], v9, s[56:59], s36 offen offset:0
  buffer_load_dwordx2 v[46:47], v9, s[56:59], s36 offen offset:2048
  buffer_load_dwordx2 v[48:49], v9, s[48:51], 0 offen offset:0
  buffer_load_dwordx2 v[50:51], v9, s[48:51], 0 offen offset:2048
  buffer_load_dwordx2 v[52:53], v9, s[48:51], s34 offen offset:0
  buffer_load_dwordx2 v[54:55], v9, s[48:51], s34 offen offset:2048
  buffer_load_dwordx2 v[56:57], v9, s[48:51], s35 offen offset:0
  buffer_load_dwordx2 v[58:59], v9, s[48:51], s35 offen offset:2048
  buffer_load_dwordx2 v[60:61], v9, s[48:51], s36 offen offset:0
  buffer_load_dwordx2 v[62:63], v9, s[48:51], s36 offen offset:2048
  s_mov_b32 s56, s66
  s_and_b32 s57, s67, 0xffff
  s_mov_b32 s58, 0x100
  s_mov_b32 s59, 0x00020000
  v_mov_b32_e64 v213, 0
  buffer_load_dwordx2 v[214:215], v213, s[56:59], 0 offen sc1
  s_mov_b32 s44, s12
  s_and_b32 s45, s13, 0xffff
  s_mov_b32 s46, 0x4000000
  s_mov_b32 s47, 0x00020000
  s_mov_b32 s66, s64
  s_mov_b32 s67, s65
  s_barrier
  s_mov_b32 s33, 0xffff0000
  s_mov_b32 s38, 0x05040100
  s_mov_b32 s39, 0x07060302
  s_mov_b32 s40, 0x3f803f80
  s_lshl_b32 s41, s2, 3
  v_add_u32 v5, s41, v0
  v_and_b32 v5, 255, v5
  v_lshlrev_b32 v5, 4, v5
  v_add_u32 v5, s3, v5
  v_add_u32 v6, 0x400000, v5
  v_mov_b32 v219, 162816
  v_mov_b32 v221, 1
  s_waitcnt vmcnt(28)
  v_lshlrev_b32 v72, 16, v64
  v_and_b32 v76, s33, v64
  v_lshlrev_b32 v80, 16, v65
  v_and_b32 v84, s33, v65
  v_lshlrev_b32 v73, 16, v66
  v_and_b32 v77, s33, v66
  v_lshlrev_b32 v81, 16, v67
  v_and_b32 v85, s33, v67
  v_lshlrev_b32 v74, 16, v68
  v_and_b32 v78, s33, v68
  v_lshlrev_b32 v82, 16, v69
  v_and_b32 v86, s33, v69
  v_lshlrev_b32 v75, 16, v70
  v_and_b32 v79, s33, v70
  v_lshlrev_b32 v83, 16, v71
  v_and_b32 v87, s33, v71
  s_waitcnt vmcnt(17)
  v_lshlrev_b32 v88, 16, v10
  v_and_b32 v89, s33, v10
  v_lshlrev_b32 v90, 16, v11
  v_and_b32 v91, s33, v11
  v_lshlrev_b32 v92, 16, v12
  v_and_b32 v93, s33, v12
  v_lshlrev_b32 v94, 16, v13
  v_and_b32 v95, s33, v13
  v_lshlrev_b32 v96, 16, v14
  v_and_b32 v97, s33, v14
  v_lshlrev_b32 v98, 16, v15
  v_and_b32 v99, s33, v15
  v_lshlrev_b32 v100, 16, v16
  v_and_b32 v101, s33, v16
  v_lshlrev_b32 v102, 16, v17
  v_and_b32 v103, s33, v17
  v_lshlrev_b32 v104, 16, v18
  v_and_b32 v105, s33, v18
  v_lshlrev_b32 v106, 16, v19
  v_and_b32 v107, s33, v19
  v_lshlrev_b32 v108, 16, v20
  v_and_b32 v109, s33, v20
  v_lshlrev_b32 v110, 16, v21
  v_and_b32 v111, s33, v21
  v_lshlrev_b32 v112, 16, v22
  v_and_b32 v113, s33, v22
  v_lshlrev_b32 v114, 16, v23
  v_and_b32 v115, s33, v23
  v_lshlrev_b32 v116, 16, v24
  v_and_b32 v117, s33, v24
  v_lshlrev_b32 v118, 16, v25
  v_and_b32 v119, s33, v25
  v_lshlrev_b32 v120, 16, v26
  v_and_b32 v121, s33, v26
  v_lshlrev_b32 v122, 16, v27
  v_and_b32 v123, s33, v27
  v_lshlrev_b32 v124, 16, v28
  v_and_b32 v125, s33, v28
  v_lshlrev_b32 v126, 16, v29
  v_and_b32 v127, s33, v29
  v_lshlrev_b32 v128, 16, v30
  v_and_b32 v129, s33, v30
  v_lshlrev_b32 v130, 16, v31
  v_and_b32_e64 v131, s33, v31
  v_pk_mul_f32 v[132:133], v[84:85], v[88:89]
  v_pk_mul_f32 v[134:135], v[86:87], v[90:91]
  v_pk_fma_f32 v[132:133], v[80:81], v[92:93], v[132:133]
  v_pk_fma_f32 v[134:135], v[82:83], v[94:95], v[134:135]
  v_pk_fma_f32 v[132:133], v[76:77], v[96:97], v[132:133]
  v_pk_fma_f32 v[134:135], v[78:79], v[98:99], v[134:135]
  v_pk_fma_f32 v[132:133], v[72:73], v[100:101], v[132:133]
  v_pk_fma_f32 v[134:135], v[74:75], v[102:103], v[134:135]
  v_pk_mul_f32 v[136:137], v[84:85], v[92:93]
  v_pk_mul_f32 v[138:139], v[86:87], v[94:95]
  v_pk_fma_f32 v[136:137], v[80:81], v[96:97], v[136:137]
  v_pk_fma_f32 v[138:139], v[82:83], v[98:99], v[138:139]
  v_pk_fma_f32 v[136:137], v[76:77], v[100:101], v[136:137]
  v_pk_fma_f32 v[138:139], v[78:79], v[102:103], v[138:139]
  v_pk_fma_f32 v[136:137], v[72:73], v[104:105], v[136:137]
  v_pk_fma_f32 v[138:139], v[74:75], v[106:107], v[138:139]
  v_pk_mul_f32 v[140:141], v[84:85], v[96:97]
  v_pk_mul_f32 v[142:143], v[86:87], v[98:99]
  v_pk_fma_f32 v[140:141], v[80:81], v[100:101], v[140:141]
  v_pk_fma_f32 v[142:143], v[82:83], v[102:103], v[142:143]
  v_pk_fma_f32 v[140:141], v[76:77], v[104:105], v[140:141]
  v_pk_fma_f32 v[142:143], v[78:79], v[106:107], v[142:143]
  v_pk_fma_f32 v[140:141], v[72:73], v[108:109], v[140:141]
  v_pk_fma_f32 v[142:143], v[74:75], v[110:111], v[142:143]
  v_pk_mul_f32 v[144:145], v[84:85], v[100:101]
  v_pk_mul_f32 v[146:147], v[86:87], v[102:103]
  v_pk_fma_f32 v[144:145], v[80:81], v[104:105], v[144:145]
  v_pk_fma_f32 v[146:147], v[82:83], v[106:107], v[146:147]
  v_pk_fma_f32 v[144:145], v[76:77], v[108:109], v[144:145]
  v_pk_fma_f32 v[146:147], v[78:79], v[110:111], v[146:147]
  v_pk_fma_f32 v[144:145], v[72:73], v[112:113], v[144:145]
  v_pk_fma_f32 v[146:147], v[74:75], v[114:115], v[146:147]
  v_pk_mul_f32 v[148:149], v[84:85], v[104:105]
  v_pk_mul_f32 v[150:151], v[86:87], v[106:107]
  v_pk_fma_f32 v[148:149], v[80:81], v[108:109], v[148:149]
  v_pk_fma_f32 v[150:151], v[82:83], v[110:111], v[150:151]
  v_pk_fma_f32 v[148:149], v[76:77], v[112:113], v[148:149]
  v_pk_fma_f32 v[150:151], v[78:79], v[114:115], v[150:151]
  v_pk_fma_f32 v[148:149], v[72:73], v[116:117], v[148:149]
  v_pk_fma_f32 v[150:151], v[74:75], v[118:119], v[150:151]
  v_pk_mul_f32 v[152:153], v[84:85], v[108:109]
  v_pk_mul_f32 v[154:155], v[86:87], v[110:111]
  v_pk_fma_f32 v[152:153], v[80:81], v[112:113], v[152:153]
  v_pk_fma_f32 v[154:155], v[82:83], v[114:115], v[154:155]
  v_pk_fma_f32 v[152:153], v[76:77], v[116:117], v[152:153]
  v_pk_fma_f32 v[154:155], v[78:79], v[118:119], v[154:155]
  v_pk_fma_f32 v[152:153], v[72:73], v[120:121], v[152:153]
  v_pk_fma_f32 v[154:155], v[74:75], v[122:123], v[154:155]
  v_pk_mul_f32 v[156:157], v[84:85], v[112:113]
  v_pk_mul_f32 v[158:159], v[86:87], v[114:115]
  v_pk_fma_f32 v[156:157], v[80:81], v[116:117], v[156:157]
  v_pk_fma_f32 v[158:159], v[82:83], v[118:119], v[158:159]
  v_pk_fma_f32 v[156:157], v[76:77], v[120:121], v[156:157]
  v_pk_fma_f32 v[158:159], v[78:79], v[122:123], v[158:159]
  v_pk_fma_f32 v[156:157], v[72:73], v[124:125], v[156:157]
  v_pk_fma_f32 v[158:159], v[74:75], v[126:127], v[158:159]
  v_pk_mul_f32 v[160:161], v[84:85], v[116:117]
  v_pk_mul_f32 v[162:163], v[86:87], v[118:119]
  v_pk_fma_f32 v[160:161], v[80:81], v[120:121], v[160:161]
  v_pk_fma_f32 v[162:163], v[82:83], v[122:123], v[162:163]
  v_pk_fma_f32 v[160:161], v[76:77], v[124:125], v[160:161]
  v_pk_fma_f32 v[162:163], v[78:79], v[126:127], v[162:163]
  v_pk_fma_f32 v[160:161], v[72:73], v[128:129], v[160:161]
  v_pk_fma_f32 v[162:163], v[74:75], v[130:131], v[162:163]
  s_waitcnt vmcnt(9)
  v_lshlrev_b32 v88, 16, v32
  v_and_b32 v89, s33, v32
  v_lshlrev_b32 v90, 16, v33
  v_and_b32 v91, s33, v33
  v_lshlrev_b32 v92, 16, v34
  v_and_b32 v93, s33, v34
  v_lshlrev_b32 v94, 16, v35
  v_and_b32 v95, s33, v35
  v_lshlrev_b32 v96, 16, v36
  v_and_b32 v97, s33, v36
  v_lshlrev_b32 v98, 16, v37
  v_and_b32 v99, s33, v37
  v_lshlrev_b32 v100, 16, v38
  v_and_b32 v101, s33, v38
  v_lshlrev_b32 v102, 16, v39
  v_and_b32 v103, s33, v39
  v_lshlrev_b32 v104, 16, v40
  v_and_b32 v105, s33, v40
  v_lshlrev_b32 v106, 16, v41
  v_and_b32 v107, s33, v41
  v_lshlrev_b32 v108, 16, v42
  v_and_b32 v109, s33, v42
  v_lshlrev_b32 v110, 16, v43
  v_and_b32 v111, s33, v43
  v_lshlrev_b32 v112, 16, v44
  v_and_b32 v113, s33, v44
  v_lshlrev_b32 v114, 16, v45
  v_and_b32 v115, s33, v45
  v_lshlrev_b32 v116, 16, v46
  v_and_b32 v117, s33, v46
  v_lshlrev_b32 v118, 16, v47
  v_and_b32_e64 v119, s33, v47
  v_pk_mul_f32 v[132:133], v[132:133], v[88:89]
  v_pk_mul_f32 v[134:135], v[134:135], v[90:91]
  v_pk_mul_f32 v[136:137], v[136:137], v[92:93]
  v_pk_mul_f32 v[138:139], v[138:139], v[94:95]
  v_pk_mul_f32 v[140:141], v[140:141], v[96:97]
  v_pk_mul_f32 v[142:143], v[142:143], v[98:99]
  v_pk_mul_f32 v[144:145], v[144:145], v[100:101]
  v_pk_mul_f32 v[146:147], v[146:147], v[102:103]
  v_pk_mul_f32 v[148:149], v[148:149], v[104:105]
  v_pk_mul_f32 v[150:151], v[150:151], v[106:107]
  v_pk_mul_f32 v[152:153], v[152:153], v[108:109]
  v_pk_mul_f32 v[154:155], v[154:155], v[110:111]
  v_pk_mul_f32 v[156:157], v[156:157], v[112:113]
  v_pk_mul_f32 v[158:159], v[158:159], v[114:115]
  v_pk_mul_f32 v[160:161], v[160:161], v[116:117]
  v_pk_mul_f32 v[162:163], v[162:163], v[118:119]
  v_cvt_pk_bf16_f32 v12, v160, v156
  v_cvt_pk_bf16_f32 v13, v152, v148
  v_cvt_pk_bf16_f32 v14, v144, v140
  v_cvt_pk_bf16_f32 v15, v136, v132
  v_cvt_pk_bf16_f32 v16, v161, v157
  v_cvt_pk_bf16_f32 v17, v153, v149
  v_cvt_pk_bf16_f32 v18, v145, v141
  v_cvt_pk_bf16_f32 v19, v137, v133
  v_cvt_pk_bf16_f32 v20, v162, v158
  v_cvt_pk_bf16_f32 v21, v154, v150
  v_cvt_pk_bf16_f32 v22, v146, v142
  v_cvt_pk_bf16_f32 v23, v138, v134
  v_cvt_pk_bf16_f32 v24, v163, v159
  v_cvt_pk_bf16_f32 v25, v155, v151
  v_cvt_pk_bf16_f32 v26, v147, v143
  v_cvt_pk_bf16_f32 v27, v139, v135
  buffer_store_dwordx4 v[12:15], v5, s[44:47], 0 offen sc1
  buffer_store_dwordx4 v[16:19], v5, s[44:47], s34 offen sc1
  buffer_store_dwordx4 v[20:23], v5, s[44:47], s35 offen sc1
  buffer_store_dwordx4 v[24:27], v5, s[44:47], s36 offen sc1
  s_waitcnt vmcnt(5)
  s_nop 0
  v_perm_b32 v164, v50, v48, s38
  v_perm_b32 v165, v54, v52, s38
  v_perm_b32 v166, v58, v56, s38
  v_perm_b32 v167, v62, v60, s38
  v_perm_b32 v168, v50, v48, s39
  v_perm_b32 v169, v54, v52, s39
  v_perm_b32 v170, v58, v56, s39
  v_perm_b32 v171, v62, v60, s39
  v_perm_b32 v172, v51, v49, s38
  v_perm_b32 v173, v55, v53, s38
  v_perm_b32 v174, v59, v57, s38
  v_perm_b32 v175, v63, v61, s38
  v_perm_b32 v176, v51, v49, s39
  v_perm_b32 v177, v55, v53, s39
  v_perm_b32 v178, v59, v57, s39
  v_perm_b32 v179, v63, v61, s39
  v_dot2_f32_bf16 v184, v48, s40, 0
  v_dot2_f32_bf16 v192, v48, v48, 0
  v_dot2_f32_bf16 v185, v50, s40, 0
  v_dot2_f32_bf16 v193, v50, v50, 0
  v_dot2_f32_bf16 v186, v52, s40, 0
  v_dot2_f32_bf16 v194, v52, v52, 0
  v_dot2_f32_bf16 v187, v54, s40, 0
  v_dot2_f32_bf16 v195, v54, v54, 0
  v_dot2_f32_bf16 v188, v56, s40, 0
  v_dot2_f32_bf16 v196, v56, v56, 0
  v_dot2_f32_bf16 v189, v58, s40, 0
  v_dot2_f32_bf16 v197, v58, v58, 0
  v_dot2_f32_bf16 v190, v60, s40, 0
  v_dot2_f32_bf16 v198, v60, v60, 0
  v_dot2_f32_bf16 v191, v62, s40, 0
  v_dot2_f32_bf16 v199, v62, v62, 0
  v_dot2_f32_bf16 v184, v49, s40, v184
  v_dot2_f32_bf16 v192, v49, v49, v192
  v_dot2_f32_bf16 v185, v51, s40, v185
  v_dot2_f32_bf16 v193, v51, v51, v193
  v_dot2_f32_bf16 v186, v53, s40, v186
  v_dot2_f32_bf16 v194, v53, v53, v194
  v_dot2_f32_bf16 v187, v55, s40, v187
  v_dot2_f32_bf16 v195, v55, v55, v195
  v_dot2_f32_bf16 v188, v57, s40, v188
  v_dot2_f32_bf16 v196, v57, v57, v196
  v_dot2_f32_bf16 v189, v59, s40, v189
  v_dot2_f32_bf16 v197, v59, v59, v197
  v_dot2_f32_bf16 v190, v61, s40, v190
  v_dot2_f32_bf16 v198, v61, v61, v198
  v_dot2_f32_bf16 v191, v63, s40, v191
  v_dot2_f32_bf16 v199, v63, v63, v199
  s_nop 2
  v_permlane32_swap_b32 v184, v192
  v_permlane32_swap_b32 v185, v193
  v_permlane32_swap_b32 v186, v194
  v_permlane32_swap_b32 v187, v195
  v_permlane32_swap_b32 v188, v196
  v_permlane32_swap_b32 v189, v197
  v_permlane32_swap_b32 v190, v198
  v_permlane32_swap_b32 v191, v199
  v_add_f32 v184, v184, v192
  v_add_f32 v185, v185, v193
  v_add_f32 v186, v186, v194
  v_add_f32 v187, v187, v195
  v_add_f32 v188, v188, v196
  v_add_f32 v189, v189, v197
  v_add_f32 v190, v190, v198
  v_add_f32 v191, v191, v199
  s_nop 1
  v_permlane16_swap_b32 v184, v188
  v_permlane16_swap_b32 v185, v189
  v_permlane16_swap_b32 v186, v190
  v_permlane16_swap_b32 v187, v191
  v_add_f32 v184, v184, v188
  v_add_f32 v185, v185, v189
  v_add_f32 v186, v186, v190
  v_add_f32 v187, v187, v191
  v_add_f32_dpp v184, v184, v184 row_ror:8 row_mask:0xf bank_mask:0xf
  v_add_f32_dpp v185, v185, v185 row_ror:8 row_mask:0xf bank_mask:0xf
  v_add_f32_dpp v186, v186, v186 row_ror:8 row_mask:0xf bank_mask:0xf
  v_add_f32_dpp v187, v187, v187 row_ror:8 row_mask:0xf bank_mask:0xf
  v_add_f32_dpp v184, v184, v184 row_ror:4 row_mask:0xf bank_mask:0xf
  v_add_f32_dpp v185, v185, v185 row_ror:4 row_mask:0xf bank_mask:0xf
  v_add_f32_dpp v186, v186, v186 row_ror:4 row_mask:0xf bank_mask:0xf
  v_add_f32_dpp v187, v187, v187 row_ror:4 row_mask:0xf bank_mask:0xf
  v_add_f32_dpp v184, v184, v184 row_ror:2 row_mask:0xf bank_mask:0xf
  v_add_f32_dpp v185, v185, v185 row_ror:2 row_mask:0xf bank_mask:0xf
  v_add_f32_dpp v186, v186, v186 row_ror:2 row_mask:0xf bank_mask:0xf
  v_add_f32_dpp v187, v187, v187 row_ror:2 row_mask:0xf bank_mask:0xf
  v_add_f32_dpp v184, v184, v184 row_ror:1 row_mask:0xf bank_mask:0xf
  v_add_f32_dpp v185, v185, v185 row_ror:1 row_mask:0xf bank_mask:0xf
  v_add_f32_dpp v186, v186, v186 row_ror:1 row_mask:0xf bank_mask:0xf
  v_add_f32_dpp v187, v187, v187 row_ror:1 row_mask:0xf bank_mask:0xf
  v_and_b32 v8, 0xf0, v0
  s_waitcnt vmcnt(0)
  s_mov_b64 exec, 1
  ds_add_rtn_u32 v216, v219, v221 offset:48
  s_waitcnt lgkmcnt(0)
  v_readfirstlane_b32 s20, v216
  s_mov_b64 exec, -1
  s_cmp_eq_u32 s20, 3
  s_cbranch_scc0 P1_K_N
  s_mov_b32 s3, 0
  v_mov_b32_e64 v213, 0
P1_K_T:
  v_readfirstlane_b32 s20, v215
  s_add_u32 s3, s3, 1
  s_cmp_eq_u32 s20, 1
  s_cbranch_scc1 P1_K_T_G
  s_cmp_ge_u32 s3, 0x200000
  s_cbranch_scc1 P1_K_T_G
  buffer_load_dwordx2 v[214:215], v213, s[56:59], 0 offen sc1
  s_waitcnt vmcnt(0)
  s_branch P1_K_T
P1_K_T_G:
  s_lshl_b32 s20, s2, 4
  s_add_u32 s20, s20, 0x992000
  v_lshlrev_b32 v216, 12, v1
  v_add_u32 v216, s20, v216
  s_mov_b64 exec, 0xff
  buffer_store_dword v214, v216, s[44:47], 0 offen sc1
  s_mov_b64 exec, -1
P1_K_N:
  v_mov_b32 v212, v6
  buffer_store_dwordx4 v[164:167], v212, s[44:47], 0 offen sc1
  buffer_store_dwordx4 v[168:171], v212, s[44:47], s34 offen sc1
  buffer_store_dwordx4 v[172:175], v212, s[44:47], s35 offen sc1
  buffer_store_dwordx4 v[176:179], v212, s[44:47], s36 offen sc1
P1_NOX:
  s_mov_b32 exec_lo, 0x00010001
  s_mov_b32 exec_hi, 0x00010001
  ds_write_b128 v8, v[184:187]
  s_waitcnt lgkmcnt(0)
  s_mov_b64 exec, 1
  ds_add_rtn_u32 v7, v219, v221 offset:4
  s_waitcnt lgkmcnt(0)
  v_readfirstlane_b32 s20, v7
  s_nop 0
  s_cmp_eq_u32 s20, 3
  s_cbranch_scc0 P1_NOST
  s_mov_b64 exec, 0xff
  v_lshlrev_b32 v8, 2, v1
  ds_read_b32 v184, v8 offset:0
  ds_read_b32 v188, v8 offset:32
  ds_read_b32 v185, v8 offset:64
  ds_read_b32 v189, v8 offset:96
  ds_read_b32 v186, v8 offset:128
  ds_read_b32 v190, v8 offset:160
  ds_read_b32 v187, v8 offset:192
  ds_read_b32 v191, v8 offset:224
  s_lshl_b32 s3, s2, 5
  s_add_u32 s3, s3, 0x800000
  v_add_u32 v8, s3, v8
  s_waitcnt lgkmcnt(0)
  v_add_f32 v184, v184, v185
  v_add_f32 v186, v186, v187
  v_add_f32 v184, v184, v186
  v_add_f32 v188, v188, v189
  v_add_f32 v190, v190, v191
  v_add_f32_e64 v188, v188, v190
  v_mul_f32 v184, 0x3a800000, v184
  v_mul_f32 v188, 0x3a800000, v188
  v_fma_f32 v188, -v184, v184, v188
  v_max_f32_e64 v188, 0, v188
  v_cvt_pk_bf16_f32 v189, v188, v188
  v_lshlrev_b32_e64 v189, 16, v189
  v_add_f32 v189, 0x3727c5ac, v189
  v_cvt_pk_bf16_f32 v189, v189, v189
  v_lshlrev_b32_e64 v189, 16, v189
  v_sqrt_f32 v189, v189
  s_nop 0
  v_cvt_pk_bf16_f32 v184, v184, v189
  v_and_b32 v185, s33, v184
  v_rcp_f32 v185, v185
  v_lshlrev_b32 v184, 16, v184
  s_nop 0
  v_mul_f32 v184, v184, v185
  v_sub_f32 v184, 0, v184
  buffer_store_dword v185, v8, s[44:47], 0 offen sc1
  buffer_store_dword v184, v8, s[44:47], s35 offen sc1
P1_NOST:
  s_mov_b64 exec, -1
  s_setprio 2
  s_lshl_b32 s20, s19, 1
  s_and_b32 s20, s20, 0xfffffffc
  s_add_u32 s10, s10, s20
  s_addc_u32 s11, s11, 0
  s_load_dword s21, s[10:11], 0
  v_and_b32 v2, 15, v1
  v_lshrrev_b32 v3, 4, v1
  v_and_b32 v4, 1, v3
  v_lshrrev_b32 v5, 1, v3
  v_sub_u32 v6, 3, v2
  v_and_b32 v6, 3, v6
  v_mul_u32_u24 v6, 4160, v6
  v_lshrrev_b32_e64 v7, 2, v2
  v_lshl_add_u32 v6, v7, 3, v6
  v_lshl_add_u32 v6, v5, 5, v6
  v_lshlrev_b32 v7, 4, v4
  v_sub_u32 v6, v6, v7
  s_mul_i32 s20, s17, 16640
  s_add_u32 s20, s20, 45080
  v_add_u32 v6, s20, v6
  v_lshlrev_b32 v7, 1, v5
  v_sub_u32 v7, v7, v4
  v_lshlrev_b32 v12, 1, v2
  v_sub_u32 v7, v7, v12
  v_add_u32 v7, 31, v7
  s_mov_b32 s32, 111616
  v_add_u32 v12, 0, v7
  v_lshrrev_b32 v13, 2, v12
  v_and_b32 v13, 3, v13
  v_xor_b32 v13, s17, v13
  v_lshlrev_b32 v13, 4, v13
  v_lshlrev_b32 v12, 6, v12
  v_add3_u32 v8, v12, v13, s32
  v_add_u32 v12, 4, v7
  v_lshrrev_b32 v13, 2, v12
  v_and_b32 v13, 3, v13
  v_xor_b32 v13, s17, v13
  v_lshlrev_b32 v13, 4, v13
  v_lshlrev_b32 v12, 6, v12
  v_add3_u32 v9, v12, v13, s32
  v_add_u32 v12, 8, v7
  v_lshrrev_b32 v13, 2, v12
  v_and_b32 v13, 3, v13
  v_xor_b32 v13, s17, v13
  v_lshlrev_b32 v13, 4, v13
  v_lshlrev_b32 v12, 6, v12
  v_add3_u32 v10, v12, v13, s32
  v_add_u32 v12, 12, v7
  v_lshrrev_b32 v13, 2, v12
  v_and_b32 v13, 3, v13
  v_xor_b32 v13, s17, v13
  v_lshlrev_b32 v13, 4, v13
  v_lshlrev_b32 v12, 6, v12
  v_add3_u32 v11, v12, v13, s32
  v_and_b32 v12, 3, v1
  v_xor_b32 v12, v12, v3
  s_lshl_b32 s20, s14, 2
  v_add_u32 v12, s20, v12
  v_lshrrev_b32 v13, 2, v1
  s_lshl_b32 s20, s17, 6
  s_sub_u32 s20, 207, s20
  v_sub_u32 v13, s20, v13
  s_lshl_b32 s20, s15, 12
  v_lshl_add_u32 v208, v13, 3, v12
  v_and_b32 v208, 255, v208
  v_lshlrev_b32 v208, 4, v208
  v_lshlrev_b32 v13, 14, v13
  v_add3_u32 v208, v208, v13, s20
  v_xor_b32 v209, 2048, v208
  v_lshlrev_b32 v12, 1, v2
  v_add_u32 v12, v12, v5
  v_sub_u32 v7, 31, v12
  v_lshrrev_b32 v13, 2, v7
  v_and_b32 v13, 3, v13
  v_xor_b32 v13, s17, v13
  v_lshlrev_b32 v13, 4, v13
  v_lshlrev_b32 v7, 6, v7
  v_xor_b32 v192, 1, v4
  v_lshlrev_b32 v192, 3, v192
  v_add3_u32 v192, v7, v13, v192
  v_add_u32 v192, 111616, v192
  v_lshrrev_b32 v13, 2, v12
  v_and_b32 v13, 3, v13
  v_xor_b32 v13, s17, v13
  v_lshlrev_b32 v13, 4, v13
  v_lshlrev_b32 v12, 6, v12
  v_lshlrev_b32 v193, 3, v4
  v_add3_u32 v193, v12, v13, v193
  v_add_u32 v193, 130048, v193
  v_lshlrev_b32_e64 v194, 6, v2
  v_lshl_add_u32 v194, v3, 4, v194
  v_add_u32 v194, 146432, v194
  v_mov_b32 v211, 162856
  s_and_b32 s20, s19, 7
  v_and_b32 v195, 7, v2
  v_xor_b32 v195, s20, v195
  v_lshlrev_b32 v195, 5, v195
  v_lshl_add_u32 v195, v5, 4, v195
  v_lshrrev_b32_e64 v7, 3, v2
  v_lshl_add_u32 v195, v7, 18, v195
  v_lshl_add_u32 v195, v4, 19, v195
  s_lshl_b32 s37, s19, 8
  s_add_u32 s37, s37, 0xc00000
  s_mov_b32 s33, 0xffff0000
  s_lshl_b32 s20, s2, 4
  s_add_u32 s20, s20, 0x98a000
  v_lshlrev_b32 v220, 12, v1
  v_add_u32 v220, s20, v220
  v_mov_b32_e64 v221, 1
  v_mov_b32 v219, 162816
  s_waitcnt lgkmcnt(0)
  s_lshl_b32 s20, s21, 16
  s_and_b32 s21, s21, 0xffff0000
  s_bitcmp0_b32 s15, 0
  s_cselect_b32 s22, s20, s21
  s_mov_b32 s23, s22
  s_and_b32 s8, s2, 7
  s_lshr_b32 s9, s2, 3
  s_and_b32 s14, s8, 1
  s_lshl_b32 s14, s14, 3
  s_lshr_b32 s15, s9, 2
  s_add_u32 s14, s14, s15
  s_lshr_b32 s15, s8, 1
  s_lshl_b32 s15, s15, 2
  s_and_b32 s9, s9, 3
  s_add_u32 s15, s15, s9
  s_mov_b32 s30, 45056
  s_mov_b32 s31, 4294877184
  v_lshrrev_b32 v2, 4, v1
  v_bfe_u32 v3, v1, 2, 2
  v_and_b32 v4, 3, v1
  v_and_b32 v5, 1, v2
  s_and_b32 s17, s16, 1
  s_lshr_b32 s18, s16, 1
  v_lshlrev_b32 v12, 2, v2
  v_add_u32 v12, v12, v3
  v_and_b32 v7, 7, v12
  v_lshlrev_b32 v13, 3, v4
  v_lshl_add_u32 v207, v12, 8, v13
  s_lshl_b32 s21, s17, 2
  v_xor_b32 v7, s21, v7
  v_lshl_add_u32 v200, v7, 5, v207
  v_xor_b32 v201, 32, v200
  v_xor_b32 v202, 64, v200
  v_xor_b32 v203, 96, v200
  v_lshlrev_b32_e64 v7, 5, v5
  v_mul_u32_u24 v12, 448, v12
  v_add_u32_e64 v12, v12, v13
  v_add_u32 v12, 8192, v12
  s_lshl_b32 s21, s18, 8
  v_add_u32 v13, s21, v12
  v_add_u32 v204, v13, v7
  v_sub_u32 v205, v13, v7
  s_add_u32 s21, s18, 6
  v_xor_b32 v13, s21, v5
  v_lshlrev_b32 v13, 5, v13
  v_add_u32 v206, v12, v13
  s_lshl_b32 s20, s17, 5
  v_lshrrev_b32 v13, 3, v1
  v_add_u32 v13, s20, v13
  v_and_b32 v12, 7, v1
  v_add_u32 v7, 4, v13
  v_mul_u32_u24 v7, 37, v7
  v_lshrrev_b32_e64 v7, 8, v7
  v_add_lshl_u32 v224, v13, v7, 7
  v_lshl_add_u32 v224, v12, 4, v224
  v_add_u32 v13, 8, v13
  v_add_u32 v7, 4, v13
  v_mul_u32_u24 v7, 37, v7
  v_lshrrev_b32 v7, 8, v7
  v_add_lshl_u32 v225, v13, v7, 7
  v_lshl_add_u32 v225, v12, 4, v225
  v_add_u32 v13, 8, v13
  v_add_u32 v7, 4, v13
  v_mul_u32_u24 v7, 37, v7
  v_lshrrev_b32 v7, 8, v7
  v_add_lshl_u32 v226, v13, v7, 7
  v_lshl_add_u32 v226, v12, 4, v226
  v_add_u32 v13, 8, v13
  v_add_u32 v7, 4, v13
  v_mul_u32_u24 v7, 37, v7
  v_lshrrev_b32 v7, 8, v7
  v_add_lshl_u32 v227, v13, v7, 7
  v_lshl_add_u32 v227, v12, 4, v227
  v_add_u32_e64 v13, 8, v13
  s_lshl_b32 s21, s18, 2
  s_add_u32 s20, s20, s21
  v_bfe_u32 v13, v1, 3, 1
  v_lshl_add_u32 v13, v5, 3, v13
  v_lshrrev_b32_e64 v7, 1, v2
  v_lshl_add_u32 v13, v7, 1, v13
  v_add_u32 v13, s20, v13
  v_add_u32 v7, 4, v13
  v_mul_u32_u24 v7, 37, v7
  v_lshrrev_b32 v7, 8, v7
  v_add_lshl_u32 v228, v13, v7, 7
  v_lshl_add_u32 v228, v12, 4, v228
  v_add_u32 v13, 16, v13
  v_add_u32 v7, 4, v13
  v_mul_u32_u24 v7, 37, v7
  v_lshrrev_b32 v7, 8, v7
  v_add_lshl_u32 v229, v13, v7, 7
  v_lshl_add_u32 v229, v12, 4, v229
  v_add_u32 v13, 16, v13
  v_mov_b32 v16, 0
  v_mov_b32 v17, 0
  v_mov_b32 v18, 0
  v_mov_b32 v19, 0
  v_mov_b32 v20, 0
  v_mov_b32 v21, 0
  v_mov_b32 v22, 0
  v_mov_b32 v23, 0
  v_mov_b32 v24, 0
  v_mov_b32 v25, 0
  v_mov_b32 v26, 0
  v_mov_b32 v27, 0
  v_mov_b32 v28, 0
  v_mov_b32 v29, 0
  v_mov_b32 v30, 0
  v_mov_b32 v31, 0
  v_mov_b32 v32, 0
  v_mov_b32 v33, 0
  v_mov_b32 v34, 0
  v_mov_b32 v35, 0
  v_mov_b32 v36, 0
  v_mov_b32 v37, 0
  v_mov_b32 v38, 0
  v_mov_b32 v39, 0
  v_mov_b32 v40, 0
  v_mov_b32 v41, 0
  v_mov_b32 v42, 0
  v_mov_b32 v43, 0
  v_mov_b32 v44, 0
  v_mov_b32 v45, 0
  v_mov_b32 v46, 0
  v_mov_b32_e64 v47, 0
  s_waitcnt vmcnt(0)
  s_mov_b64 exec, 1
  ds_add_rtn_u32 v216, v219, v221 offset:8
  s_waitcnt lgkmcnt(0)
  v_readfirstlane_b32 s20, v216
  s_mov_b64 exec, -1
  s_cmp_eq_u32 s20, 4
  s_cbranch_scc0 P1_C_N
  s_mov_b32 s3, 0
  v_mov_b32_e64 v213, 0
P1_C_T:
  v_readfirstlane_b32 s20, v215
  s_add_u32 s3, s3, 1
  s_cmp_eq_u32 s20, 1
  s_cbranch_scc1 P1_C_T_G
  s_cmp_ge_u32 s3, 0x200000
  s_cbranch_scc1 P1_C_T_G
  buffer_load_dwordx2 v[214:215], v213, s[56:59], 0 offen sc1
  s_waitcnt vmcnt(0)
  s_branch P1_C_T
P1_C_T_G:
  s_lshl_b32 s20, s2, 4
  s_add_u32 s20, s20, 0x99a000
  v_lshlrev_b32 v216, 12, v1
  v_add_u32 v216, s20, v216
  s_mov_b64 exec, 0xff
  buffer_store_dword v214, v216, s[44:47], 0 offen sc1
  s_mov_b64 exec, -1
P1_C_N:
  v_add_u32 v13, 12, v219
  s_mov_b32 s41, s23
  s_cmp_eq_u32 s16, 0
  s_cbranch_scc0 P1_W
  s_mov_b32 s3, 0
  v_mov_b32_e64 v213, 0
P1_T3:
  v_readfirstlane_b32 s20, v215
  s_add_u32 s3, s3, 1
  s_cmp_eq_u32 s20, 1
  s_cbranch_scc1 P1_T3_G
  s_cmp_ge_u32 s3, 0x200000
  s_cbranch_scc1 P1_T3_G
  buffer_load_dwordx2 v[214:215], v213, s[56:59], 0 offen sc1
  s_waitcnt vmcnt(0)
  s_branch P1_T3
P1_T3_G:
  v_readfirstlane_b32 s65, v214
  s_and_b32 s21, s2, 7
  s_lshl_b32 s21, s21, 12
  s_add_u32 s21, s21, 0x992000
  v_lshlrev_b32_e64 v12, 4, v1
  v_add_u32 v12, s21, v12
  s_mov_b32 s23, 0
P1_P:
  buffer_load_dword v48, v12, s[44:47], 0 offen offset:0 sc1
  buffer_load_dword v49, v12, s[44:47], 0 offen offset:1024 sc1
  buffer_load_dword v50, v12, s[44:47], 0 offen offset:2048 sc1
  buffer_load_dword v51, v12, s[44:47], 0 offen offset:3072 sc1
  s_waitcnt vmcnt(0)
  v_cmp_eq_u32 vcc, s65, v48
  s_nop 1
  s_nop 0
  v_cndmask_b32 v48, 0, 1, vcc
  v_cmp_eq_u32 vcc, s65, v49
  s_nop 1
  v_cndmask_b32 v49, 0, 1, vcc
  v_cmp_eq_u32 vcc, s65, v50
  s_nop 1
  v_cndmask_b32 v50, 0, 1, vcc
  v_cmp_eq_u32 vcc, s65, v51
  s_nop 1
  v_cndmask_b32 v51, 0, 1, vcc
  v_and_b32_e64 v48, v48, v49
  v_bitop3_b32 v48, v48, v50, v51 bitop3:0x80
  v_cmp_eq_u32 vcc, 0, v48
  s_add_u32 s23, s23, 1
  s_cmp_ge_u32 s23, 0x200000
  s_cbranch_scc1 P1_P_GOT
  s_cmp_eq_u64 vcc, 0
  s_cbranch_scc1 P1_P_GOT
  s_sleep 4
  s_branch P1_P
P1_P_GOT:
  s_mov_b64 exec, -1
  ds_write_b32 v13, v221
  s_mov_b32 s23, s41
P1_W:
P1_Q:
  ds_read_b32 v48, v13
  s_waitcnt lgkmcnt(0)
  v_readfirstlane_b32 s20, v48
  s_nop 0
  s_cmp_ge_u32 s20, 1
  s_cbranch_scc1 P1_Q_GO
  s_sleep 2
  s_branch P1_Q
P1_Q_GO:
  s_lshl_b32 s20, s16, 12
  s_add_u32 m0, s20, 111616
  s_mov_b32 s21, 0xc0000
  buffer_load_dwordx4 v209, s[44:47], s21 offen sc1 lds
  s_add_u32 m0, s20, 112640
  s_mov_b32 s21, 0x80000
  buffer_load_dwordx4 v208, s[44:47], s21 offen sc1 lds
  s_add_u32 m0, s20, 113664
  s_mov_b32 s21, 0x40000
  buffer_load_dwordx4 v209, s[44:47], s21 offen sc1 lds
  s_add_u32 m0, s20, 114688
  s_mov_b32 s21, 0x0
  buffer_load_dwordx4 v208, s[44:47], s21 offen sc1 lds
  s_waitcnt vmcnt(0)
  s_barrier
  ds_read_b64 v[48:49], v6 offset:0
  ds_read_b64 v[50:51], v6 offset:8
  ds_read_b128 v[52:55], v8 offset:14336
  ds_read_b64 v[56:57], v6 offset:512
  ds_read_b64 v[58:59], v6 offset:520
  ds_read_b128 v[60:63], v8 offset:12288
  ds_read_b64 v[64:65], v6 offset:1024
  ds_read_b64 v[66:67], v6 offset:1032
  ds_read_b128 v[68:71], v8 offset:10240
  ds_read_b64 v[72:73], v6 offset:1536
  ds_read_b64 v[74:75], v6 offset:1544
  ds_read_b128 v[76:79], v8 offset:8192
  ds_read_b64 v[80:81], v6 offset:2048
  ds_read_b64 v[82:83], v6 offset:2056
  ds_read_b128 v[84:87], v8 offset:6144
  ds_read_b64 v[88:89], v6 offset:2560
  ds_read_b64 v[90:91], v6 offset:2568
  ds_read_b128 v[92:95], v8 offset:4096
  ds_read_b64 v[96:97], v6 offset:3072
  ds_read_b64 v[98:99], v6 offset:3080
  ds_read_b128 v[100:103], v8 offset:2048
  ds_read_b64 v[104:105], v6 offset:3584
  ds_read_b64 v[106:107], v6 offset:3592
  ds_read_b128 v[108:111], v8 offset:0
  s_mov_b32 s32, 0
C_LOOP:
  s_waitcnt lgkmcnt(15)
  v_mfma_f32_16x16x32_bf16 v[16:19], v[48:51], v[52:55], v[16:19]
  v_mfma_f32_16x16x32_bf16 v[20:23], v[56:59], v[52:55], v[20:23]
  v_mfma_f32_16x16x32_bf16 v[20:23], v[48:51], v[60:63], v[20:23]
  v_mfma_f32_16x16x32_bf16 v[24:27], v[56:59], v[60:63], v[24:27]
  v_mfma_f32_16x16x32_bf16 v[24:27], v[64:67], v[52:55], v[24:27]
  ds_read_b64 v[112:113], v6 offset:64
  v_mfma_f32_16x16x32_bf16 v[24:27], v[48:51], v[68:71], v[24:27]
  ds_read_b64 v[114:115], v6 offset:72
  v_mfma_f32_16x16x32_bf16 v[28:31], v[64:67], v[60:63], v[28:31]
  ds_read_b128 v[116:119], v9 offset:14336
  v_mfma_f32_16x16x32_bf16 v[28:31], v[56:59], v[68:71], v[28:31]
  ds_read_b64 v[120:121], v6 offset:576
  v_mfma_f32_16x16x32_bf16 v[32:35], v[64:67], v[68:71], v[32:35]
  ds_read_b64 v[122:123], v6 offset:584
  s_waitcnt lgkmcnt(15)
  v_mfma_f32_16x16x32_bf16 v[28:31], v[72:75], v[52:55], v[28:31]
  ds_read_b128 v[124:127], v9 offset:12288
  v_mfma_f32_16x16x32_bf16 v[28:31], v[48:51], v[76:79], v[28:31]
  ds_read_b64 v[128:129], v6 offset:1088
  v_mfma_f32_16x16x32_bf16 v[32:35], v[72:75], v[60:63], v[32:35]
  ds_read_b64 v[130:131], v6 offset:1096
  v_mfma_f32_16x16x32_bf16 v[32:35], v[56:59], v[76:79], v[32:35]
  ds_read_b128 v[132:135], v9 offset:10240
  v_mfma_f32_16x16x32_bf16 v[36:39], v[72:75], v[68:71], v[36:39]
  ds_read_b64 v[136:137], v6 offset:1600
  v_mfma_f32_16x16x32_bf16 v[36:39], v[64:67], v[76:79], v[36:39]
  ds_read_b64 v[138:139], v6 offset:1608
  v_mfma_f32_16x16x32_bf16 v[40:43], v[72:75], v[76:79], v[40:43]
  ds_read_b128 v[140:143], v9 offset:8192
  v_mfma_f32_16x16x32_bf16 v[32:35], v[80:83], v[52:55], v[32:35]
  ds_read_b64 v[144:145], v6 offset:2112
  s_waitcnt lgkmcnt(15)
  v_mfma_f32_16x16x32_bf16 v[32:35], v[48:51], v[84:87], v[32:35]
  ds_read_b64 v[146:147], v6 offset:2120
  v_mfma_f32_16x16x32_bf16 v[36:39], v[80:83], v[60:63], v[36:39]
  ds_read_b128 v[148:151], v9 offset:6144
  v_mfma_f32_16x16x32_bf16 v[36:39], v[56:59], v[84:87], v[36:39]
  ds_read_b64 v[152:153], v6 offset:2624
  v_mfma_f32_16x16x32_bf16 v[40:43], v[80:83], v[68:71], v[40:43]
  ds_read_b64 v[154:155], v6 offset:2632
  v_mfma_f32_16x16x32_bf16 v[40:43], v[64:67], v[84:87], v[40:43]
  ds_read_b128 v[156:159], v9 offset:4096
  v_mfma_f32_16x16x32_bf16 v[44:47], v[80:83], v[76:79], v[44:47]
  ds_read_b64 v[160:161], v6 offset:3136
  v_mfma_f32_16x16x32_bf16 v[44:47], v[72:75], v[84:87], v[44:47]
  ds_read_b64 v[162:163], v6 offset:3144
  v_mfma_f32_16x16x32_bf16 v[36:39], v[88:91], v[52:55], v[36:39]
  ds_read_b128 v[164:167], v9 offset:2048
  v_mfma_f32_16x16x32_bf16 v[36:39], v[48:51], v[92:95], v[36:39]
  ds_read_b64 v[168:169], v6 offset:3648
  v_mfma_f32_16x16x32_bf16 v[40:43], v[88:91], v[60:63], v[40:43]
  ds_read_b64 v[170:171], v6 offset:3656
  v_mfma_f32_16x16x32_bf16 v[40:43], v[56:59], v[92:95], v[40:43]
  ds_read_b128 v[172:175], v9 offset:0
  v_mfma_f32_16x16x32_bf16 v[44:47], v[88:91], v[68:71], v[44:47]
  v_mfma_f32_16x16x32_bf16 v[44:47], v[64:67], v[92:95], v[44:47]
  v_mfma_f32_16x16x32_bf16 v[40:43], v[96:99], v[52:55], v[40:43]
  v_mfma_f32_16x16x32_bf16 v[40:43], v[48:51], v[100:103], v[40:43]
  v_mfma_f32_16x16x32_bf16 v[44:47], v[96:99], v[60:63], v[44:47]
  v_mfma_f32_16x16x32_bf16 v[44:47], v[56:59], v[100:103], v[44:47]
  s_waitcnt lgkmcnt(15)
  v_mfma_f32_16x16x32_bf16 v[44:47], v[104:107], v[52:55], v[44:47]
  v_mfma_f32_16x16x32_bf16 v[44:47], v[48:51], v[108:111], v[44:47]
  v_mfma_f32_16x16x32_bf16 v[16:19], v[112:115], v[116:119], v[16:19]
  v_mfma_f32_16x16x32_bf16 v[20:23], v[120:123], v[116:119], v[20:23]
  v_mfma_f32_16x16x32_bf16 v[20:23], v[112:115], v[124:127], v[20:23]
  v_mfma_f32_16x16x32_bf16 v[24:27], v[120:123], v[124:127], v[24:27]
  v_mfma_f32_16x16x32_bf16 v[24:27], v[128:131], v[116:119], v[24:27]
  ds_read_b64 v[48:49], v6 offset:128
  v_mfma_f32_16x16x32_bf16 v[24:27], v[112:115], v[132:135], v[24:27]
  ds_read_b64 v[50:51], v6 offset:136
  v_mfma_f32_16x16x32_bf16 v[28:31], v[128:131], v[124:127], v[28:31]
  ds_read_b128 v[52:55], v10 offset:14336
  v_mfma_f32_16x16x32_bf16 v[28:31], v[120:123], v[132:135], v[28:31]
  ds_read_b64 v[56:57], v6 offset:640
  v_mfma_f32_16x16x32_bf16 v[32:35], v[128:131], v[132:135], v[32:35]
  ds_read_b64 v[58:59], v6 offset:648
  s_waitcnt lgkmcnt(15)
  v_mfma_f32_16x16x32_bf16 v[28:31], v[136:139], v[116:119], v[28:31]
  ds_read_b128 v[60:63], v10 offset:12288
  v_mfma_f32_16x16x32_bf16 v[28:31], v[112:115], v[140:143], v[28:31]
  ds_read_b64 v[64:65], v6 offset:1152
  v_mfma_f32_16x16x32_bf16 v[32:35], v[136:139], v[124:127], v[32:35]
  ds_read_b64 v[66:67], v6 offset:1160
  v_mfma_f32_16x16x32_bf16 v[32:35], v[120:123], v[140:143], v[32:35]
  ds_read_b128 v[68:71], v10 offset:10240
  v_mfma_f32_16x16x32_bf16 v[36:39], v[136:139], v[132:135], v[36:39]
  ds_read_b64 v[72:73], v6 offset:1664
  v_mfma_f32_16x16x32_bf16 v[36:39], v[128:131], v[140:143], v[36:39]
  ds_read_b64 v[74:75], v6 offset:1672
  v_mfma_f32_16x16x32_bf16 v[40:43], v[136:139], v[140:143], v[40:43]
  ds_read_b128 v[76:79], v10 offset:8192
  v_mfma_f32_16x16x32_bf16 v[32:35], v[144:147], v[116:119], v[32:35]
  ds_read_b64 v[80:81], v6 offset:2176
  s_waitcnt lgkmcnt(15)
  v_mfma_f32_16x16x32_bf16 v[32:35], v[112:115], v[148:151], v[32:35]
  ds_read_b64 v[82:83], v6 offset:2184
  v_mfma_f32_16x16x32_bf16 v[36:39], v[144:147], v[124:127], v[36:39]
  ds_read_b128 v[84:87], v10 offset:6144
  v_mfma_f32_16x16x32_bf16 v[36:39], v[120:123], v[148:151], v[36:39]
  ds_read_b64 v[88:89], v6 offset:2688
  v_mfma_f32_16x16x32_bf16 v[40:43], v[144:147], v[132:135], v[40:43]
  ds_read_b64 v[90:91], v6 offset:2696
  v_mfma_f32_16x16x32_bf16 v[40:43], v[128:131], v[148:151], v[40:43]
  ds_read_b128 v[92:95], v10 offset:4096
  v_mfma_f32_16x16x32_bf16 v[44:47], v[144:147], v[140:143], v[44:47]
  ds_read_b64 v[96:97], v6 offset:3200
  v_mfma_f32_16x16x32_bf16 v[44:47], v[136:139], v[148:151], v[44:47]
  ds_read_b64 v[98:99], v6 offset:3208
  v_mfma_f32_16x16x32_bf16 v[36:39], v[152:155], v[116:119], v[36:39]
  ds_read_b128 v[100:103], v10 offset:2048
  v_mfma_f32_16x16x32_bf16 v[36:39], v[112:115], v[156:159], v[36:39]
  ds_read_b64 v[104:105], v6 offset:3712
  v_mfma_f32_16x16x32_bf16 v[40:43], v[152:155], v[124:127], v[40:43]
  ds_read_b64 v[106:107], v6 offset:3720
  v_mfma_f32_16x16x32_bf16 v[40:43], v[120:123], v[156:159], v[40:43]
  ds_read_b128 v[108:111], v10 offset:0
  v_mfma_f32_16x16x32_bf16 v[44:47], v[152:155], v[132:135], v[44:47]
  v_mfma_f32_16x16x32_bf16 v[44:47], v[128:131], v[156:159], v[44:47]
  v_mfma_f32_16x16x32_bf16 v[40:43], v[160:163], v[116:119], v[40:43]
  v_mfma_f32_16x16x32_bf16 v[40:43], v[112:115], v[164:167], v[40:43]
  v_mfma_f32_16x16x32_bf16 v[44:47], v[160:163], v[124:127], v[44:47]
  v_mfma_f32_16x16x32_bf16 v[44:47], v[120:123], v[164:167], v[44:47]
  s_waitcnt lgkmcnt(15)
  v_mfma_f32_16x16x32_bf16 v[44:47], v[168:171], v[116:119], v[44:47]
  v_mfma_f32_16x16x32_bf16 v[44:47], v[112:115], v[172:175], v[44:47]
  v_mfma_f32_16x16x32_bf16 v[16:19], v[48:51], v[52:55], v[16:19]
  v_mfma_f32_16x16x32_bf16 v[20:23], v[56:59], v[52:55], v[20:23]
  v_mfma_f32_16x16x32_bf16 v[20:23], v[48:51], v[60:63], v[20:23]
  v_mfma_f32_16x16x32_bf16 v[24:27], v[56:59], v[60:63], v[24:27]
  v_mfma_f32_16x16x32_bf16 v[24:27], v[64:67], v[52:55], v[24:27]
  ds_read_b64 v[112:113], v6 offset:192
  v_mfma_f32_16x16x32_bf16 v[24:27], v[48:51], v[68:71], v[24:27]
  ds_read_b64 v[114:115], v6 offset:200
  v_mfma_f32_16x16x32_bf16 v[28:31], v[64:67], v[60:63], v[28:31]
  ds_read_b128 v[116:119], v11 offset:14336
  v_mfma_f32_16x16x32_bf16 v[28:31], v[56:59], v[68:71], v[28:31]
  ds_read_b64 v[120:121], v6 offset:704
  v_mfma_f32_16x16x32_bf16 v[32:35], v[64:67], v[68:71], v[32:35]
  ds_read_b64 v[122:123], v6 offset:712
  s_waitcnt lgkmcnt(15)
  v_mfma_f32_16x16x32_bf16 v[28:31], v[72:75], v[52:55], v[28:31]
  ds_read_b128 v[124:127], v11 offset:12288
  v_mfma_f32_16x16x32_bf16 v[28:31], v[48:51], v[76:79], v[28:31]
  ds_read_b64 v[128:129], v6 offset:1216
  v_mfma_f32_16x16x32_bf16 v[32:35], v[72:75], v[60:63], v[32:35]
  ds_read_b64 v[130:131], v6 offset:1224
  v_mfma_f32_16x16x32_bf16 v[32:35], v[56:59], v[76:79], v[32:35]
  ds_read_b128 v[132:135], v11 offset:10240
  v_mfma_f32_16x16x32_bf16 v[36:39], v[72:75], v[68:71], v[36:39]
  ds_read_b64 v[136:137], v6 offset:1728
  v_mfma_f32_16x16x32_bf16 v[36:39], v[64:67], v[76:79], v[36:39]
  ds_read_b64 v[138:139], v6 offset:1736
  v_mfma_f32_16x16x32_bf16 v[40:43], v[72:75], v[76:79], v[40:43]
  ds_read_b128 v[140:143], v11 offset:8192
  v_mfma_f32_16x16x32_bf16 v[32:35], v[80:83], v[52:55], v[32:35]
  ds_read_b64 v[144:145], v6 offset:2240
  s_waitcnt lgkmcnt(15)
  v_mfma_f32_16x16x32_bf16 v[32:35], v[48:51], v[84:87], v[32:35]
  ds_read_b64 v[146:147], v6 offset:2248
  v_mfma_f32_16x16x32_bf16 v[36:39], v[80:83], v[60:63], v[36:39]
  ds_read_b128 v[148:151], v11 offset:6144
  v_mfma_f32_16x16x32_bf16 v[36:39], v[56:59], v[84:87], v[36:39]
  ds_read_b64 v[152:153], v6 offset:2752
  v_mfma_f32_16x16x32_bf16 v[40:43], v[80:83], v[68:71], v[40:43]
  ds_read_b64 v[154:155], v6 offset:2760
  v_mfma_f32_16x16x32_bf16 v[40:43], v[64:67], v[84:87], v[40:43]
  ds_read_b128 v[156:159], v11 offset:4096
  v_mfma_f32_16x16x32_bf16 v[44:47], v[80:83], v[76:79], v[44:47]
  ds_read_b64 v[160:161], v6 offset:3264
  v_mfma_f32_16x16x32_bf16 v[44:47], v[72:75], v[84:87], v[44:47]
  ds_read_b64 v[162:163], v6 offset:3272
  v_mfma_f32_16x16x32_bf16 v[36:39], v[88:91], v[52:55], v[36:39]
  ds_read_b128 v[164:167], v11 offset:2048
  v_mfma_f32_16x16x32_bf16 v[36:39], v[48:51], v[92:95], v[36:39]
  ds_read_b64 v[168:169], v6 offset:3776
  v_mfma_f32_16x16x32_bf16 v[40:43], v[88:91], v[60:63], v[40:43]
  ds_read_b64 v[170:171], v6 offset:3784
  v_mfma_f32_16x16x32_bf16 v[40:43], v[56:59], v[92:95], v[40:43]
  ds_read_b128 v[172:175], v11 offset:0
  v_mfma_f32_16x16x32_bf16 v[44:47], v[88:91], v[68:71], v[44:47]
  v_mfma_f32_16x16x32_bf16 v[44:47], v[64:67], v[92:95], v[44:47]
  v_mfma_f32_16x16x32_bf16 v[40:43], v[96:99], v[52:55], v[40:43]
  v_mfma_f32_16x16x32_bf16 v[40:43], v[48:51], v[100:103], v[40:43]
  v_mfma_f32_16x16x32_bf16 v[44:47], v[96:99], v[60:63], v[44:47]
  v_mfma_f32_16x16x32_bf16 v[44:47], v[56:59], v[100:103], v[44:47]
  s_waitcnt lgkmcnt(15)
  v_mfma_f32_16x16x32_bf16 v[44:47], v[104:107], v[52:55], v[44:47]
  v_mfma_f32_16x16x32_bf16 v[44:47], v[48:51], v[108:111], v[44:47]
  v_mfma_f32_16x16x32_bf16 v[16:19], v[112:115], v[116:119], v[16:19]
  v_mfma_f32_16x16x32_bf16 v[20:23], v[120:123], v[116:119], v[20:23]
  v_mfma_f32_16x16x32_bf16 v[20:23], v[112:115], v[124:127], v[20:23]
  v_mfma_f32_16x16x32_bf16 v[24:27], v[120:123], v[124:127], v[24:27]
  v_mfma_f32_16x16x32_bf16 v[24:27], v[128:131], v[116:119], v[24:27]
  ds_read_b64 v[48:49], v6 offset:256
  v_mfma_f32_16x16x32_bf16 v[24:27], v[112:115], v[132:135], v[24:27]
  ds_read_b64 v[50:51], v6 offset:264
  v_mfma_f32_16x16x32_bf16 v[28:31], v[128:131], v[124:127], v[28:31]
  ds_read_b128 v[52:55], v8 offset:15360
  v_mfma_f32_16x16x32_bf16 v[28:31], v[120:123], v[132:135], v[28:31]
  ds_read_b64 v[56:57], v6 offset:768
  v_mfma_f32_16x16x32_bf16 v[32:35], v[128:131], v[132:135], v[32:35]
  ds_read_b64 v[58:59], v6 offset:776
  s_waitcnt lgkmcnt(15)
  v_mfma_f32_16x16x32_bf16 v[28:31], v[136:139], v[116:119], v[28:31]
  ds_read_b128 v[60:63], v8 offset:13312
  v_mfma_f32_16x16x32_bf16 v[28:31], v[112:115], v[140:143], v[28:31]
  ds_read_b64 v[64:65], v6 offset:1280
  v_mfma_f32_16x16x32_bf16 v[32:35], v[136:139], v[124:127], v[32:35]
  ds_read_b64 v[66:67], v6 offset:1288
  v_mfma_f32_16x16x32_bf16 v[32:35], v[120:123], v[140:143], v[32:35]
  ds_read_b128 v[68:71], v8 offset:11264
  v_mfma_f32_16x16x32_bf16 v[36:39], v[136:139], v[132:135], v[36:39]
  ds_read_b64 v[72:73], v6 offset:1792
  v_mfma_f32_16x16x32_bf16 v[36:39], v[128:131], v[140:143], v[36:39]
  ds_read_b64 v[74:75], v6 offset:1800
  v_mfma_f32_16x16x32_bf16 v[40:43], v[136:139], v[140:143], v[40:43]
  ds_read_b128 v[76:79], v8 offset:9216
  v_mfma_f32_16x16x32_bf16 v[32:35], v[144:147], v[116:119], v[32:35]
  ds_read_b64 v[80:81], v6 offset:2304
  s_waitcnt lgkmcnt(15)
  v_mfma_f32_16x16x32_bf16 v[32:35], v[112:115], v[148:151], v[32:35]
  ds_read_b64 v[82:83], v6 offset:2312
  v_mfma_f32_16x16x32_bf16 v[36:39], v[144:147], v[124:127], v[36:39]
  ds_read_b128 v[84:87], v8 offset:7168
  v_mfma_f32_16x16x32_bf16 v[36:39], v[120:123], v[148:151], v[36:39]
  ds_read_b64 v[88:89], v6 offset:2816
  v_mfma_f32_16x16x32_bf16 v[40:43], v[144:147], v[132:135], v[40:43]
  ds_read_b64 v[90:91], v6 offset:2824
  v_mfma_f32_16x16x32_bf16 v[40:43], v[128:131], v[148:151], v[40:43]
  ds_read_b128 v[92:95], v8 offset:5120
  v_mfma_f32_16x16x32_bf16 v[44:47], v[144:147], v[140:143], v[44:47]
  ds_read_b64 v[96:97], v6 offset:3328
  v_mfma_f32_16x16x32_bf16 v[44:47], v[136:139], v[148:151], v[44:47]
  ds_read_b64 v[98:99], v6 offset:3336
  v_mfma_f32_16x16x32_bf16 v[36:39], v[152:155], v[116:119], v[36:39]
  ds_read_b128 v[100:103], v8 offset:3072
  v_mfma_f32_16x16x32_bf16 v[36:39], v[112:115], v[156:159], v[36:39]
  ds_read_b64 v[104:105], v6 offset:3840
  v_mfma_f32_16x16x32_bf16 v[40:43], v[152:155], v[124:127], v[40:43]
  ds_read_b64 v[106:107], v6 offset:3848
  v_mfma_f32_16x16x32_bf16 v[40:43], v[120:123], v[156:159], v[40:43]
  ds_read_b128 v[108:111], v8 offset:1024
  v_mfma_f32_16x16x32_bf16 v[44:47], v[152:155], v[132:135], v[44:47]
  s_nop 0
  v_add_u32 v6, 256, v6
  v_mfma_f32_16x16x32_bf16 v[44:47], v[128:131], v[156:159], v[44:47]
  v_add_u32 v8, 1024, v8
  v_mfma_f32_16x16x32_bf16 v[40:43], v[160:163], v[116:119], v[40:43]
  v_add_u32 v9, 1024, v9
  v_mfma_f32_16x16x32_bf16 v[40:43], v[112:115], v[164:167], v[40:43]
  v_add_u32 v10, 1024, v10
  v_mfma_f32_16x16x32_bf16 v[44:47], v[160:163], v[124:127], v[44:47]
  v_add_u32 v11, 1024, v11
  v_mfma_f32_16x16x32_bf16 v[44:47], v[120:123], v[164:167], v[44:47]
  s_waitcnt lgkmcnt(15)
  v_mfma_f32_16x16x32_bf16 v[44:47], v[168:171], v[116:119], v[44:47]
  v_mfma_f32_16x16x32_bf16 v[44:47], v[112:115], v[172:175], v[44:47]
  s_add_u32 s32, s32, 1
  s_cmp_lt_u32 s32, 2
  s_cbranch_scc1 C_LOOP
  s_add_u32 s38, s37, 0x100000
  s_add_u32 s39, s38, 0x100000
  s_add_u32 s40, s39, 0x100000
C_SF:
  ds_read_b32 v12, v211
  s_waitcnt lgkmcnt(0)
  v_readfirstlane_b32 s20, v12
  s_nop 0
  s_cmp_ge_u32 s20, 4
  s_cbranch_scc1 C_SF_GO
  s_sleep 2
  s_branch C_SF
C_SF_GO:
  ds_read_b64 v[48:49], v192 offset:14336
  ds_read_b64 v[64:65], v193 offset:0
  ds_read_b128 v[80:83], v194 offset:0
  ds_read_b128 v[84:87], v194 offset:8192
  ds_read_b64 v[50:51], v192 offset:12288
  ds_read_b64 v[66:67], v193 offset:2048
  ds_read_b128 v[88:91], v194 offset:1024
  ds_read_b128 v[92:95], v194 offset:9216
  ds_read_b64 v[52:53], v192 offset:10240
  ds_read_b64 v[68:69], v193 offset:4096
  ds_read_b128 v[96:99], v194 offset:2048
  ds_read_b128 v[100:103], v194 offset:10240
  ds_read_b64 v[54:55], v192 offset:8192
  ds_read_b64 v[70:71], v193 offset:6144
  ds_read_b128 v[104:107], v194 offset:3072
  ds_read_b128 v[108:111], v194 offset:11264
  ds_read_b64 v[56:57], v192 offset:6144
  ds_read_b64 v[72:73], v193 offset:8192
  ds_read_b128 v[112:115], v194 offset:4096
  ds_read_b128 v[116:119], v194 offset:12288
  ds_read_b64 v[58:59], v192 offset:4096
  ds_read_b64 v[74:75], v193 offset:10240
  ds_read_b128 v[120:123], v194 offset:5120
  ds_read_b128 v[124:127], v194 offset:13312
  ds_read_b64 v[60:61], v192 offset:2048
  ds_read_b64 v[76:77], v193 offset:12288
  ds_read_b128 v[128:131], v194 offset:6144
  ds_read_b128 v[132:135], v194 offset:14336
  ds_read_b64 v[62:63], v192 offset:0
  ds_read_b64 v[78:79], v193 offset:14336
  ds_read_b128 v[136:139], v194 offset:7168
  ds_read_b128 v[140:143], v194 offset:15360
  s_waitcnt lgkmcnt(15)
  v_and_b32 v144, s33, v49
  v_lshlrev_b32 v145, 16, v49
  v_and_b32 v146, s33, v48
  v_lshlrev_b32 v147, 16, v48
  v_lshlrev_b32 v148, 16, v64
  v_and_b32 v149, s33, v64
  v_lshlrev_b32 v150, 16, v65
  v_and_b32 v151, s33, v65
  v_pk_fma_f32 v[16:17], v[144:145], s[22:23], v[16:17]
  v_pk_fma_f32 v[18:19], v[146:147], s[22:23], v[18:19]
  v_pk_fma_f32 v[80:81], v[148:149], v[80:81], v[84:85]
  v_pk_fma_f32 v[82:83], v[150:151], v[82:83], v[86:87]
  v_pk_fma_f32 v[16:17], v[80:81], v[16:17], v[148:149]
  v_pk_fma_f32 v[18:19], v[82:83], v[18:19], v[150:151]
  v_cvt_pk_bf16_f32 v176, v16, v17
  v_cvt_pk_bf16_f32 v177, v18, v19
  v_and_b32 v152, s33, v51
  v_lshlrev_b32 v153, 16, v51
  v_and_b32 v154, s33, v50
  v_lshlrev_b32 v155, 16, v50
  v_lshlrev_b32 v156, 16, v66
  v_and_b32 v157, s33, v66
  v_lshlrev_b32 v158, 16, v67
  v_and_b32 v159, s33, v67
  v_pk_fma_f32 v[20:21], v[152:153], s[22:23], v[20:21]
  v_pk_fma_f32 v[22:23], v[154:155], s[22:23], v[22:23]
  v_pk_fma_f32 v[88:89], v[156:157], v[88:89], v[92:93]
  v_pk_fma_f32 v[90:91], v[158:159], v[90:91], v[94:95]
  v_pk_fma_f32 v[20:21], v[88:89], v[20:21], v[156:157]
  v_pk_fma_f32 v[22:23], v[90:91], v[22:23], v[158:159]
  v_cvt_pk_bf16_f32 v178, v20, v21
  v_cvt_pk_bf16_f32 v179, v22, v23
  s_nop 1
  v_permlane16_swap_b32 v176, v178
  v_permlane16_swap_b32 v177, v179
  buffer_store_dwordx4 v[176:179], v195, s[44:47], s37 offen sc1
  v_and_b32 v144, s33, v53
  v_lshlrev_b32 v145, 16, v53
  v_and_b32 v146, s33, v52
  v_lshlrev_b32 v147, 16, v52
  v_lshlrev_b32 v148, 16, v68
  v_and_b32 v149, s33, v68
  v_lshlrev_b32 v150, 16, v69
  v_and_b32_e64 v151, s33, v69
  v_pk_fma_f32 v[24:25], v[144:145], s[22:23], v[24:25]
  v_pk_fma_f32 v[26:27], v[146:147], s[22:23], v[26:27]
  v_pk_fma_f32 v[96:97], v[148:149], v[96:97], v[100:101]
  v_pk_fma_f32 v[98:99], v[150:151], v[98:99], v[102:103]
  v_pk_fma_f32 v[24:25], v[96:97], v[24:25], v[148:149]
  v_pk_fma_f32 v[26:27], v[98:99], v[26:27], v[150:151]
  v_cvt_pk_bf16_f32 v180, v24, v25
  v_cvt_pk_bf16_f32 v181, v26, v27
  v_and_b32 v152, s33, v55
  v_lshlrev_b32 v153, 16, v55
  v_and_b32 v154, s33, v54
  v_lshlrev_b32 v155, 16, v54
  v_lshlrev_b32 v156, 16, v70
  v_and_b32 v157, s33, v70
  v_lshlrev_b32 v158, 16, v71
  v_and_b32 v159, s33, v71
  v_pk_fma_f32 v[28:29], v[152:153], s[22:23], v[28:29]
  v_pk_fma_f32 v[30:31], v[154:155], s[22:23], v[30:31]
  v_pk_fma_f32 v[104:105], v[156:157], v[104:105], v[108:109]
  v_pk_fma_f32 v[106:107], v[158:159], v[106:107], v[110:111]
  v_pk_fma_f32 v[28:29], v[104:105], v[28:29], v[156:157]
  v_pk_fma_f32 v[30:31], v[106:107], v[30:31], v[158:159]
  v_cvt_pk_bf16_f32 v182, v28, v29
  v_cvt_pk_bf16_f32 v183, v30, v31
  s_nop 1
  v_permlane16_swap_b32 v180, v182
  v_permlane16_swap_b32 v181, v183
  buffer_store_dwordx4 v[180:183], v195, s[44:47], s38 offen sc1
  s_waitcnt lgkmcnt(12)
  v_and_b32 v144, s33, v57
  v_lshlrev_b32 v145, 16, v57
  v_and_b32 v146, s33, v56
  v_lshlrev_b32 v147, 16, v56
  v_lshlrev_b32 v148, 16, v72
  v_and_b32 v149, s33, v72
  v_lshlrev_b32 v150, 16, v73
  v_and_b32 v151, s33, v73
  v_pk_fma_f32 v[32:33], v[144:145], s[22:23], v[32:33]
  v_pk_fma_f32 v[34:35], v[146:147], s[22:23], v[34:35]
  v_pk_fma_f32 v[112:113], v[148:149], v[112:113], v[116:117]
  v_pk_fma_f32 v[114:115], v[150:151], v[114:115], v[118:119]
  v_pk_fma_f32 v[32:33], v[112:113], v[32:33], v[148:149]
  v_pk_fma_f32 v[34:35], v[114:115], v[34:35], v[150:151]
  v_cvt_pk_bf16_f32 v184, v32, v33
  v_cvt_pk_bf16_f32 v185, v34, v35
  s_waitcnt lgkmcnt(8)
  v_and_b32 v152, s33, v59
  v_lshlrev_b32 v153, 16, v59
  v_and_b32 v154, s33, v58
  v_lshlrev_b32 v155, 16, v58
  v_lshlrev_b32 v156, 16, v74
  v_and_b32 v157, s33, v74
  v_lshlrev_b32 v158, 16, v75
  v_and_b32_e64 v159, s33, v75
  v_pk_fma_f32 v[36:37], v[152:153], s[22:23], v[36:37]
  v_pk_fma_f32 v[38:39], v[154:155], s[22:23], v[38:39]
  v_pk_fma_f32 v[120:121], v[156:157], v[120:121], v[124:125]
  v_pk_fma_f32 v[122:123], v[158:159], v[122:123], v[126:127]
  v_pk_fma_f32 v[36:37], v[120:121], v[36:37], v[156:157]
  v_pk_fma_f32 v[38:39], v[122:123], v[38:39], v[158:159]
  v_cvt_pk_bf16_f32 v186, v36, v37
  v_cvt_pk_bf16_f32 v187, v38, v39
  s_nop 1
  v_permlane16_swap_b32 v184, v186
  v_permlane16_swap_b32 v185, v187
  buffer_store_dwordx4 v[184:187], v195, s[44:47], s39 offen sc1
  s_waitcnt lgkmcnt(4)
  v_and_b32 v144, s33, v61
  v_lshlrev_b32 v145, 16, v61
  v_and_b32 v146, s33, v60
  v_lshlrev_b32 v147, 16, v60
  v_lshlrev_b32 v148, 16, v76
  v_and_b32 v149, s33, v76
  v_lshlrev_b32 v150, 16, v77
  v_and_b32 v151, s33, v77
  v_pk_fma_f32 v[40:41], v[144:145], s[22:23], v[40:41]
  v_pk_fma_f32 v[42:43], v[146:147], s[22:23], v[42:43]
  v_pk_fma_f32 v[128:129], v[148:149], v[128:129], v[132:133]
  v_pk_fma_f32 v[130:131], v[150:151], v[130:131], v[134:135]
  v_pk_fma_f32 v[40:41], v[128:129], v[40:41], v[148:149]
  v_pk_fma_f32 v[42:43], v[130:131], v[42:43], v[150:151]
  v_cvt_pk_bf16_f32 v188, v40, v41
  v_cvt_pk_bf16_f32 v189, v42, v43
  s_waitcnt lgkmcnt(0)
  v_and_b32 v152, s33, v63
  v_lshlrev_b32 v153, 16, v63
  v_and_b32 v154, s33, v62
  v_lshlrev_b32 v155, 16, v62
  v_lshlrev_b32 v156, 16, v78
  v_and_b32 v157, s33, v78
  v_lshlrev_b32 v158, 16, v79
  v_and_b32_e64 v159, s33, v79
  v_pk_fma_f32 v[44:45], v[152:153], s[22:23], v[44:45]
  v_pk_fma_f32 v[46:47], v[154:155], s[22:23], v[46:47]
  v_pk_fma_f32 v[136:137], v[156:157], v[136:137], v[140:141]
  v_pk_fma_f32 v[138:139], v[158:159], v[138:139], v[142:143]
  v_pk_fma_f32 v[44:45], v[136:137], v[44:45], v[156:157]
  v_pk_fma_f32 v[46:47], v[138:139], v[46:47], v[158:159]
  v_cvt_pk_bf16_f32 v190, v44, v45
  v_cvt_pk_bf16_f32 v191, v46, v47
  s_nop 1
  v_permlane16_swap_b32 v188, v190
  v_permlane16_swap_b32 v189, v191
  buffer_store_dwordx4 v[188:191], v195, s[44:47], s40 offen sc1
  s_mov_b64 exec, 1
  ds_add_u32 v219, v221
  s_mov_b64 exec, -1
  v_mov_b32 v8, v200
  v_mov_b32 v9, v201
  v_mov_b32 v10, v202
  v_mov_b32 v11, v203
  v_mov_b32 v12, v204
  v_mov_b32 v13, v205
  v_mov_b32 v14, v206
  s_waitcnt vmcnt(0)
  s_mov_b64 exec, 1
  ds_add_rtn_u32 v218, v219, v221 offset:32
  s_waitcnt lgkmcnt(0)
  v_readfirstlane_b32 s20, v218
  s_nop 0
  s_cmp_eq_u32 s20, 3
  s_cbranch_scc0 C_NOSIG
  s_mov_b64 exec, 0xff
  buffer_store_dword v221, v220, s[44:47], 0 offen sc1
C_NOSIG:
  s_mov_b64 exec, -1
  s_barrier
  s_mov_b32 s34, 0
  s_mov_b32 s32, 1
  s_mov_b32 s36, 99
  ds_read_b64_tr_b16 v[16:17], v8 offset:0
  ds_read_b64_tr_b16 v[18:19], v8 offset:4096
  ds_read_b64_tr_b16 v[32:33], v12 offset:0
  ds_read_b64_tr_b16 v[34:35], v12 offset:7168
  ds_read_b64_tr_b16 v[36:37], v13 offset:32
  ds_read_b64_tr_b16 v[38:39], v13 offset:7200
  ds_read_b64_tr_b16 v[40:41], v12 offset:64
  ds_read_b64_tr_b16 v[42:43], v12 offset:7232
  ds_read_b64_tr_b16 v[44:45], v13 offset:96
  ds_read_b64_tr_b16 v[46:47], v13 offset:7264
  ds_read_b64_tr_b16 v[48:49], v12 offset:128
  ds_read_b64_tr_b16 v[50:51], v12 offset:7296
  ds_read_b64_tr_b16 v[52:53], v13 offset:160
  ds_read_b64_tr_b16 v[54:55], v13 offset:7328
  ds_read_b64_tr_b16 v[56:57], v14 offset:0
  ds_read_b64_tr_b16 v[58:59], v14 offset:7168
  ds_read_b64_tr_b16 v[20:21], v9 offset:0
  ds_read_b64_tr_b16 v[22:23], v9 offset:4096
  ds_read_b64_tr_b16 v[24:25], v10 offset:0
  ds_read_b64_tr_b16 v[26:27], v10 offset:4096
  ds_read_b64_tr_b16 v[28:29], v11 offset:0
  ds_read_b64_tr_b16 v[30:31], v11 offset:4096
  s_waitcnt lgkmcnt(15)
  v_mfma_f32_16x16x32_bf16 v[104:107], v[32:35], v[16:19], 0
  ds_read_b64_tr_b16 v[60:61], v8 offset:22528
  v_mfma_f32_16x16x32_bf16 v[120:123], v[36:39], v[16:19], 0
  ds_read_b64_tr_b16 v[62:63], v8 offset:26624
  s_waitcnt lgkmcnt(15)
  v_mfma_f32_16x16x32_bf16 v[136:139], v[40:43], v[16:19], 0
  ds_read_b64_tr_b16 v[76:77], v12 offset:22528
  s_waitcnt lgkmcnt(15)
  v_mfma_f32_16x16x32_bf16 v[152:155], v[44:47], v[16:19], 0
  ds_read_b64_tr_b16 v[78:79], v12 offset:29696
  s_waitcnt lgkmcnt(14)
  v_mfma_f32_16x16x32_bf16 v[168:171], v[48:51], v[16:19], 0
  ds_read_b64_tr_b16 v[80:81], v13 offset:22560
  s_waitcnt lgkmcnt(13)
  v_mfma_f32_16x16x32_bf16 v[184:187], v[52:55], v[16:19], 0
  ds_read_b64_tr_b16 v[82:83], v13 offset:29728
  s_waitcnt lgkmcnt(12)
  v_mfma_f32_16x16x32_bf16 v[200:203], v[56:59], v[16:19], 0
  ds_read_b64_tr_b16 v[84:85], v12 offset:22592
  s_waitcnt lgkmcnt(11)
  v_mfma_f32_16x16x32_bf16 v[108:111], v[32:35], v[20:23], 0
  ds_read_b64_tr_b16 v[86:87], v12 offset:29760
  v_mfma_f32_16x16x32_bf16 v[124:127], v[36:39], v[20:23], 0
  ds_read_b64_tr_b16 v[88:89], v13 offset:22624
  v_mfma_f32_16x16x32_bf16 v[140:143], v[40:43], v[20:23], 0
  ds_read_b64_tr_b16 v[90:91], v13 offset:29792
  v_mfma_f32_16x16x32_bf16 v[156:159], v[44:47], v[20:23], 0
  ds_read_b64_tr_b16 v[92:93], v12 offset:22656
  v_mfma_f32_16x16x32_bf16 v[172:175], v[48:51], v[20:23], 0
  ds_read_b64_tr_b16 v[94:95], v12 offset:29824
  v_mfma_f32_16x16x32_bf16 v[188:191], v[52:55], v[20:23], 0
  ds_read_b64_tr_b16 v[96:97], v13 offset:22688
  v_mfma_f32_16x16x32_bf16 v[204:207], v[56:59], v[20:23], 0
  ds_read_b64_tr_b16 v[98:99], v13 offset:29856
  s_waitcnt lgkmcnt(15)
  v_mfma_f32_16x16x32_bf16 v[112:115], v[32:35], v[24:27], 0
  ds_read_b64_tr_b16 v[100:101], v14 offset:22528
  v_mfma_f32_16x16x32_bf16 v[128:131], v[36:39], v[24:27], 0
  ds_read_b64_tr_b16 v[102:103], v14 offset:29696
  v_mfma_f32_16x16x32_bf16 v[144:147], v[40:43], v[24:27], 0
  ds_read_b64_tr_b16 v[64:65], v9 offset:22528
  v_mfma_f32_16x16x32_bf16 v[160:163], v[44:47], v[24:27], 0
  ds_read_b64_tr_b16 v[66:67], v9 offset:26624
  v_mfma_f32_16x16x32_bf16 v[176:179], v[48:51], v[24:27], 0
  ds_read_b64_tr_b16 v[68:69], v10 offset:22528
  v_mfma_f32_16x16x32_bf16 v[192:195], v[52:55], v[24:27], 0
  ds_read_b64_tr_b16 v[70:71], v10 offset:26624
  v_mfma_f32_16x16x32_bf16 v[208:211], v[56:59], v[24:27], 0
  ds_read_b64_tr_b16 v[72:73], v11 offset:22528
  s_waitcnt lgkmcnt(15)
  v_mfma_f32_16x16x32_bf16 v[116:119], v[32:35], v[28:31], 0
  ds_read_b64_tr_b16 v[74:75], v11 offset:26624
  v_mfma_f32_16x16x32_bf16 v[132:135], v[36:39], v[28:31], 0
  v_mfma_f32_16x16x32_bf16 v[148:151], v[40:43], v[28:31], 0
  v_mfma_f32_16x16x32_bf16 v[164:167], v[44:47], v[28:31], 0
  v_mfma_f32_16x16x32_bf16 v[180:183], v[48:51], v[28:31], 0
  v_mfma_f32_16x16x32_bf16 v[196:199], v[52:55], v[28:31], 0
  v_mfma_f32_16x16x32_bf16 v[212:215], v[56:59], v[28:31], 0
  v_mfma_f32_16x16x32_bf16 v[104:107], v[76:79], v[60:63], v[104:107]
  s_add_u32 s34, s34, 1
  s_cmp_eq_u32 s34, 3
  s_cselect_b32 s35, s31, s30
  s_cselect_b32 s34, 0, s34
  v_add_u32_e64 v8, s35, v8
  v_mfma_f32_16x16x32_bf16 v[120:123], v[80:83], v[60:63], v[120:123]
  v_add_u32_e64 v9, s35, v9
  v_add_u32 v10, s35, v10
  s_waitcnt lgkmcnt(14)
  v_mfma_f32_16x16x32_bf16 v[136:139], v[84:87], v[60:63], v[136:139]
  v_add_u32_e64 v11, s35, v11
  v_add_u32 v12, s35, v12
  s_waitcnt lgkmcnt(12)
  v_mfma_f32_16x16x32_bf16 v[152:155], v[88:91], v[60:63], v[152:155]
  v_add_u32 v13, s35, v13
  v_add_u32 v14, s35, v14
  s_waitcnt lgkmcnt(0)
  s_barrier
  v_mfma_f32_16x16x32_bf16 v[168:171], v[92:95], v[60:63], v[168:171]
  ds_read_b64_tr_b16 v[16:17], v8 offset:0
  v_mfma_f32_16x16x32_bf16 v[184:187], v[96:99], v[60:63], v[184:187]
  ds_read_b64_tr_b16 v[18:19], v8 offset:4096
  v_mfma_f32_16x16x32_bf16 v[200:203], v[100:103], v[60:63], v[200:203]
  ds_read_b64_tr_b16 v[32:33], v12 offset:0
  v_mfma_f32_16x16x32_bf16 v[108:111], v[76:79], v[64:67], v[108:111]
  ds_read_b64_tr_b16 v[34:35], v12 offset:7168
  v_mfma_f32_16x16x32_bf16 v[124:127], v[80:83], v[64:67], v[124:127]
  ds_read_b64_tr_b16 v[36:37], v13 offset:32
  v_mfma_f32_16x16x32_bf16 v[140:143], v[84:87], v[64:67], v[140:143]
  ds_read_b64_tr_b16 v[38:39], v13 offset:7200
  v_mfma_f32_16x16x32_bf16 v[156:159], v[88:91], v[64:67], v[156:159]
  ds_read_b64_tr_b16 v[40:41], v12 offset:64
  v_mfma_f32_16x16x32_bf16 v[172:175], v[92:95], v[64:67], v[172:175]
  ds_read_b64_tr_b16 v[42:43], v12 offset:7232
  v_mfma_f32_16x16x32_bf16 v[188:191], v[96:99], v[64:67], v[188:191]
  ds_read_b64_tr_b16 v[44:45], v13 offset:96
  v_mfma_f32_16x16x32_bf16 v[204:207], v[100:103], v[64:67], v[204:207]
  ds_read_b64_tr_b16 v[46:47], v13 offset:7264
  v_mfma_f32_16x16x32_bf16 v[112:115], v[76:79], v[68:71], v[112:115]
  ds_read_b64_tr_b16 v[48:49], v12 offset:128
  v_mfma_f32_16x16x32_bf16 v[128:131], v[80:83], v[68:71], v[128:131]
  ds_read_b64_tr_b16 v[50:51], v12 offset:7296
  v_mfma_f32_16x16x32_bf16 v[144:147], v[84:87], v[68:71], v[144:147]
  ds_read_b64_tr_b16 v[52:53], v13 offset:160
  v_mfma_f32_16x16x32_bf16 v[160:163], v[88:91], v[68:71], v[160:163]
  ds_read_b64_tr_b16 v[54:55], v13 offset:7328
  v_mfma_f32_16x16x32_bf16 v[176:179], v[92:95], v[68:71], v[176:179]
  ds_read_b64_tr_b16 v[56:57], v14 offset:0
  v_mfma_f32_16x16x32_bf16 v[192:195], v[96:99], v[68:71], v[192:195]
  ds_read_b64_tr_b16 v[58:59], v14 offset:7168
  v_mfma_f32_16x16x32_bf16 v[208:211], v[100:103], v[68:71], v[208:211]
  ds_read_b64_tr_b16 v[20:21], v9 offset:0
  v_mfma_f32_16x16x32_bf16 v[116:119], v[76:79], v[72:75], v[116:119]
  ds_read_b64_tr_b16 v[22:23], v9 offset:4096
  v_mfma_f32_16x16x32_bf16 v[132:135], v[80:83], v[72:75], v[132:135]
  ds_read_b64_tr_b16 v[24:25], v10 offset:0
  v_mfma_f32_16x16x32_bf16 v[148:151], v[84:87], v[72:75], v[148:151]
  ds_read_b64_tr_b16 v[26:27], v10 offset:4096
  v_mfma_f32_16x16x32_bf16 v[164:167], v[88:91], v[72:75], v[164:167]
  ds_read_b64_tr_b16 v[28:29], v11 offset:0
  v_mfma_f32_16x16x32_bf16 v[180:183], v[92:95], v[72:75], v[180:183]
  ds_read_b64_tr_b16 v[30:31], v11 offset:4096
  v_mfma_f32_16x16x32_bf16 v[196:199], v[96:99], v[72:75], v[196:199]
  v_mfma_f32_16x16x32_bf16 v[212:215], v[100:103], v[72:75], v[212:215]
A_CLOOP:
  s_waitcnt lgkmcnt(15)
  v_mfma_f32_16x16x32_bf16 v[104:107], v[32:35], v[16:19], v[104:107]
  ds_read_b64_tr_b16 v[60:61], v8 offset:22528
  v_mfma_f32_16x16x32_bf16 v[120:123], v[36:39], v[16:19], v[120:123]
  ds_read_b64_tr_b16 v[62:63], v8 offset:26624
  s_waitcnt lgkmcnt(15)
  v_mfma_f32_16x16x32_bf16 v[136:139], v[40:43], v[16:19], v[136:139]
  ds_read_b64_tr_b16 v[76:77], v12 offset:22528
  s_waitcnt lgkmcnt(15)
  v_mfma_f32_16x16x32_bf16 v[152:155], v[44:47], v[16:19], v[152:155]
  ds_read_b64_tr_b16 v[78:79], v12 offset:29696
  s_waitcnt lgkmcnt(14)
  v_mfma_f32_16x16x32_bf16 v[168:171], v[48:51], v[16:19], v[168:171]
  ds_read_b64_tr_b16 v[80:81], v13 offset:22560
  s_waitcnt lgkmcnt(13)
  v_mfma_f32_16x16x32_bf16 v[184:187], v[52:55], v[16:19], v[184:187]
  ds_read_b64_tr_b16 v[82:83], v13 offset:29728
  s_waitcnt lgkmcnt(12)
  v_mfma_f32_16x16x32_bf16 v[200:203], v[56:59], v[16:19], v[200:203]
  ds_read_b64_tr_b16 v[84:85], v12 offset:22592
  s_waitcnt lgkmcnt(11)
  v_mfma_f32_16x16x32_bf16 v[108:111], v[32:35], v[20:23], v[108:111]
  ds_read_b64_tr_b16 v[86:87], v12 offset:29760
  v_mfma_f32_16x16x32_bf16 v[124:127], v[36:39], v[20:23], v[124:127]
  ds_read_b64_tr_b16 v[88:89], v13 offset:22624
  v_mfma_f32_16x16x32_bf16 v[140:143], v[40:43], v[20:23], v[140:143]
  ds_read_b64_tr_b16 v[90:91], v13 offset:29792
  v_mfma_f32_16x16x32_bf16 v[156:159], v[44:47], v[20:23], v[156:159]
  ds_read_b64_tr_b16 v[92:93], v12 offset:22656
  v_mfma_f32_16x16x32_bf16 v[172:175], v[48:51], v[20:23], v[172:175]
  ds_read_b64_tr_b16 v[94:95], v12 offset:29824
  v_mfma_f32_16x16x32_bf16 v[188:191], v[52:55], v[20:23], v[188:191]
  ds_read_b64_tr_b16 v[96:97], v13 offset:22688
  v_mfma_f32_16x16x32_bf16 v[204:207], v[56:59], v[20:23], v[204:207]
  ds_read_b64_tr_b16 v[98:99], v13 offset:29856
  s_waitcnt lgkmcnt(15)
  v_mfma_f32_16x16x32_bf16 v[112:115], v[32:35], v[24:27], v[112:115]
  ds_read_b64_tr_b16 v[100:101], v14 offset:22528
  v_mfma_f32_16x16x32_bf16 v[128:131], v[36:39], v[24:27], v[128:131]
  ds_read_b64_tr_b16 v[102:103], v14 offset:29696
  v_mfma_f32_16x16x32_bf16 v[144:147], v[40:43], v[24:27], v[144:147]
  ds_read_b64_tr_b16 v[64:65], v9 offset:22528
  v_mfma_f32_16x16x32_bf16 v[160:163], v[44:47], v[24:27], v[160:163]
  ds_read_b64_tr_b16 v[66:67], v9 offset:26624
  v_mfma_f32_16x16x32_bf16 v[176:179], v[48:51], v[24:27], v[176:179]
  ds_read_b64_tr_b16 v[68:69], v10 offset:22528
  v_mfma_f32_16x16x32_bf16 v[192:195], v[52:55], v[24:27], v[192:195]
  ds_read_b64_tr_b16 v[70:71], v10 offset:26624
  v_mfma_f32_16x16x32_bf16 v[208:211], v[56:59], v[24:27], v[208:211]
  ds_read_b64_tr_b16 v[72:73], v11 offset:22528
  s_waitcnt lgkmcnt(15)
  v_mfma_f32_16x16x32_bf16 v[116:119], v[32:35], v[28:31], v[116:119]
  ds_read_b64_tr_b16 v[74:75], v11 offset:26624
  v_mfma_f32_16x16x32_bf16 v[132:135], v[36:39], v[28:31], v[132:135]
  v_mfma_f32_16x16x32_bf16 v[148:151], v[40:43], v[28:31], v[148:151]
  v_mfma_f32_16x16x32_bf16 v[164:167], v[44:47], v[28:31], v[164:167]
  v_mfma_f32_16x16x32_bf16 v[180:183], v[48:51], v[28:31], v[180:183]
  v_mfma_f32_16x16x32_bf16 v[196:199], v[52:55], v[28:31], v[196:199]
  v_mfma_f32_16x16x32_bf16 v[212:215], v[56:59], v[28:31], v[212:215]
  v_mfma_f32_16x16x32_bf16 v[104:107], v[76:79], v[60:63], v[104:107]
  s_add_u32 s34, s34, 1
  s_cmp_eq_u32 s34, 3
  s_cselect_b32 s35, s31, s30
  s_cselect_b32 s34, 0, s34
  v_add_u32 v8, s35, v8
  v_mfma_f32_16x16x32_bf16 v[120:123], v[80:83], v[60:63], v[120:123]
  v_add_u32_e64 v9, s35, v9
  v_add_u32 v10, s35, v10
  s_waitcnt lgkmcnt(14)
  v_mfma_f32_16x16x32_bf16 v[136:139], v[84:87], v[60:63], v[136:139]
  v_add_u32_e64 v11, s35, v11
  v_add_u32 v12, s35, v12
  s_waitcnt lgkmcnt(12)
  v_mfma_f32_16x16x32_bf16 v[152:155], v[88:91], v[60:63], v[152:155]
  v_add_u32 v13, s35, v13
  v_add_u32 v14, s35, v14
  s_waitcnt lgkmcnt(0)
  s_barrier
  v_mfma_f32_16x16x32_bf16 v[168:171], v[92:95], v[60:63], v[168:171]
  ds_read_b64_tr_b16 v[16:17], v8 offset:0
  v_mfma_f32_16x16x32_bf16 v[184:187], v[96:99], v[60:63], v[184:187]
  ds_read_b64_tr_b16 v[18:19], v8 offset:4096
  v_mfma_f32_16x16x32_bf16 v[200:203], v[100:103], v[60:63], v[200:203]
  ds_read_b64_tr_b16 v[32:33], v12 offset:0
  v_mfma_f32_16x16x32_bf16 v[108:111], v[76:79], v[64:67], v[108:111]
  ds_read_b64_tr_b16 v[34:35], v12 offset:7168
  v_mfma_f32_16x16x32_bf16 v[124:127], v[80:83], v[64:67], v[124:127]
  ds_read_b64_tr_b16 v[36:37], v13 offset:32
  v_mfma_f32_16x16x32_bf16 v[140:143], v[84:87], v[64:67], v[140:143]
  ds_read_b64_tr_b16 v[38:39], v13 offset:7200
  v_mfma_f32_16x16x32_bf16 v[156:159], v[88:91], v[64:67], v[156:159]
  ds_read_b64_tr_b16 v[40:41], v12 offset:64
  v_mfma_f32_16x16x32_bf16 v[172:175], v[92:95], v[64:67], v[172:175]
  ds_read_b64_tr_b16 v[42:43], v12 offset:7232
  v_mfma_f32_16x16x32_bf16 v[188:191], v[96:99], v[64:67], v[188:191]
  ds_read_b64_tr_b16 v[44:45], v13 offset:96
  v_mfma_f32_16x16x32_bf16 v[204:207], v[100:103], v[64:67], v[204:207]
  ds_read_b64_tr_b16 v[46:47], v13 offset:7264
  v_mfma_f32_16x16x32_bf16 v[112:115], v[76:79], v[68:71], v[112:115]
  ds_read_b64_tr_b16 v[48:49], v12 offset:128
  v_mfma_f32_16x16x32_bf16 v[128:131], v[80:83], v[68:71], v[128:131]
  ds_read_b64_tr_b16 v[50:51], v12 offset:7296
  v_mfma_f32_16x16x32_bf16 v[144:147], v[84:87], v[68:71], v[144:147]
  ds_read_b64_tr_b16 v[52:53], v13 offset:160
  v_mfma_f32_16x16x32_bf16 v[160:163], v[88:91], v[68:71], v[160:163]
  ds_read_b64_tr_b16 v[54:55], v13 offset:7328
  v_mfma_f32_16x16x32_bf16 v[176:179], v[92:95], v[68:71], v[176:179]
  ds_read_b64_tr_b16 v[56:57], v14 offset:0
  v_mfma_f32_16x16x32_bf16 v[192:195], v[96:99], v[68:71], v[192:195]
  ds_read_b64_tr_b16 v[58:59], v14 offset:7168
  v_mfma_f32_16x16x32_bf16 v[208:211], v[100:103], v[68:71], v[208:211]
  ds_read_b64_tr_b16 v[20:21], v9 offset:0
  v_mfma_f32_16x16x32_bf16 v[116:119], v[76:79], v[72:75], v[116:119]
  ds_read_b64_tr_b16 v[22:23], v9 offset:4096
  v_mfma_f32_16x16x32_bf16 v[132:135], v[80:83], v[72:75], v[132:135]
  ds_read_b64_tr_b16 v[24:25], v10 offset:0
  v_mfma_f32_16x16x32_bf16 v[148:151], v[84:87], v[72:75], v[148:151]
  ds_read_b64_tr_b16 v[26:27], v10 offset:4096
  v_mfma_f32_16x16x32_bf16 v[164:167], v[88:91], v[72:75], v[164:167]
  ds_read_b64_tr_b16 v[28:29], v11 offset:0
  v_mfma_f32_16x16x32_bf16 v[180:183], v[92:95], v[72:75], v[180:183]
  ds_read_b64_tr_b16 v[30:31], v11 offset:4096
  v_mfma_f32_16x16x32_bf16 v[196:199], v[96:99], v[72:75], v[196:199]
  v_mfma_f32_16x16x32_bf16 v[212:215], v[100:103], v[72:75], v[212:215]
  s_add_u32 s32, s32, 1
  s_cmp_lt_u32 s32, 15
  s_cbranch_scc1 A_CLOOP
  s_waitcnt lgkmcnt(15)
  v_mfma_f32_16x16x32_bf16 v[104:107], v[32:35], v[16:19], v[104:107]
  ds_read_b64_tr_b16 v[60:61], v8 offset:22528
  v_mfma_f32_16x16x32_bf16 v[120:123], v[36:39], v[16:19], v[120:123]
  ds_read_b64_tr_b16 v[62:63], v8 offset:26624
  s_waitcnt lgkmcnt(15)
  v_mfma_f32_16x16x32_bf16 v[136:139], v[40:43], v[16:19], v[136:139]
  ds_read_b64_tr_b16 v[76:77], v12 offset:22528
  s_waitcnt lgkmcnt(15)
  v_mfma_f32_16x16x32_bf16 v[152:155], v[44:47], v[16:19], v[152:155]
  ds_read_b64_tr_b16 v[78:79], v12 offset:29696
  s_waitcnt lgkmcnt(14)
  v_mfma_f32_16x16x32_bf16 v[168:171], v[48:51], v[16:19], v[168:171]
  ds_read_b64_tr_b16 v[80:81], v13 offset:22560
  s_waitcnt lgkmcnt(13)
  v_mfma_f32_16x16x32_bf16 v[184:187], v[52:55], v[16:19], v[184:187]
  ds_read_b64_tr_b16 v[82:83], v13 offset:29728
  s_waitcnt lgkmcnt(12)
  v_mfma_f32_16x16x32_bf16 v[200:203], v[56:59], v[16:19], v[200:203]
  ds_read_b64_tr_b16 v[84:85], v12 offset:22592
  s_waitcnt lgkmcnt(11)
  v_mfma_f32_16x16x32_bf16 v[108:111], v[32:35], v[20:23], v[108:111]
  ds_read_b64_tr_b16 v[86:87], v12 offset:29760
  v_mfma_f32_16x16x32_bf16 v[124:127], v[36:39], v[20:23], v[124:127]
  ds_read_b64_tr_b16 v[88:89], v13 offset:22624
  v_mfma_f32_16x16x32_bf16 v[140:143], v[40:43], v[20:23], v[140:143]
  ds_read_b64_tr_b16 v[90:91], v13 offset:29792
  v_mfma_f32_16x16x32_bf16 v[156:159], v[44:47], v[20:23], v[156:159]
  ds_read_b64_tr_b16 v[92:93], v12 offset:22656
  v_mfma_f32_16x16x32_bf16 v[172:175], v[48:51], v[20:23], v[172:175]
  ds_read_b64_tr_b16 v[94:95], v12 offset:29824
  v_mfma_f32_16x16x32_bf16 v[188:191], v[52:55], v[20:23], v[188:191]
  ds_read_b64_tr_b16 v[96:97], v13 offset:22688
  v_mfma_f32_16x16x32_bf16 v[204:207], v[56:59], v[20:23], v[204:207]
  ds_read_b64_tr_b16 v[98:99], v13 offset:29856
  s_waitcnt lgkmcnt(15)
  v_mfma_f32_16x16x32_bf16 v[112:115], v[32:35], v[24:27], v[112:115]
  ds_read_b64_tr_b16 v[100:101], v14 offset:22528
  v_mfma_f32_16x16x32_bf16 v[128:131], v[36:39], v[24:27], v[128:131]
  ds_read_b64_tr_b16 v[102:103], v14 offset:29696
  v_mfma_f32_16x16x32_bf16 v[144:147], v[40:43], v[24:27], v[144:147]
  ds_read_b64_tr_b16 v[64:65], v9 offset:22528
  v_mfma_f32_16x16x32_bf16 v[160:163], v[44:47], v[24:27], v[160:163]
  ds_read_b64_tr_b16 v[66:67], v9 offset:26624
  v_mfma_f32_16x16x32_bf16 v[176:179], v[48:51], v[24:27], v[176:179]
  ds_read_b64_tr_b16 v[68:69], v10 offset:22528
  v_mfma_f32_16x16x32_bf16 v[192:195], v[52:55], v[24:27], v[192:195]
  ds_read_b64_tr_b16 v[70:71], v10 offset:26624
  v_mfma_f32_16x16x32_bf16 v[208:211], v[56:59], v[24:27], v[208:211]
  ds_read_b64_tr_b16 v[72:73], v11 offset:22528
  s_waitcnt lgkmcnt(15)
  v_mfma_f32_16x16x32_bf16 v[116:119], v[32:35], v[28:31], v[116:119]
  ds_read_b64_tr_b16 v[74:75], v11 offset:26624
  v_mfma_f32_16x16x32_bf16 v[132:135], v[36:39], v[28:31], v[132:135]
  v_mfma_f32_16x16x32_bf16 v[148:151], v[40:43], v[28:31], v[148:151]
  v_mfma_f32_16x16x32_bf16 v[164:167], v[44:47], v[28:31], v[164:167]
  v_mfma_f32_16x16x32_bf16 v[180:183], v[48:51], v[28:31], v[180:183]
  v_mfma_f32_16x16x32_bf16 v[196:199], v[52:55], v[28:31], v[196:199]
  v_mfma_f32_16x16x32_bf16 v[212:215], v[56:59], v[28:31], v[212:215]
  v_mfma_f32_16x16x32_bf16 v[104:107], v[76:79], v[60:63], v[104:107]
  v_mfma_f32_16x16x32_bf16 v[120:123], v[80:83], v[60:63], v[120:123]
  s_waitcnt lgkmcnt(14)
  v_mfma_f32_16x16x32_bf16 v[136:139], v[84:87], v[60:63], v[136:139]
  s_waitcnt lgkmcnt(12)
  v_mfma_f32_16x16x32_bf16 v[152:155], v[88:91], v[60:63], v[152:155]
  s_waitcnt lgkmcnt(10)
  v_mfma_f32_16x16x32_bf16 v[168:171], v[92:95], v[60:63], v[168:171]
  s_waitcnt lgkmcnt(8)
  v_mfma_f32_16x16x32_bf16 v[184:187], v[96:99], v[60:63], v[184:187]
  s_waitcnt lgkmcnt(6)
  v_mfma_f32_16x16x32_bf16 v[200:203], v[100:103], v[60:63], v[200:203]
  s_waitcnt lgkmcnt(4)
  v_mfma_f32_16x16x32_bf16 v[108:111], v[76:79], v[64:67], v[108:111]
  v_mfma_f32_16x16x32_bf16 v[124:127], v[80:83], v[64:67], v[124:127]
  v_mfma_f32_16x16x32_bf16 v[140:143], v[84:87], v[64:67], v[140:143]
  v_mfma_f32_16x16x32_bf16 v[156:159], v[88:91], v[64:67], v[156:159]
  v_mfma_f32_16x16x32_bf16 v[172:175], v[92:95], v[64:67], v[172:175]
  v_mfma_f32_16x16x32_bf16 v[188:191], v[96:99], v[64:67], v[188:191]
  v_mfma_f32_16x16x32_bf16 v[204:207], v[100:103], v[64:67], v[204:207]
  s_waitcnt lgkmcnt(2)
  v_mfma_f32_16x16x32_bf16 v[112:115], v[76:79], v[68:71], v[112:115]
  v_and_b32 v6, 15, v1
  v_lshlrev_b32 v6, 4, v6
  s_lshl_b32 s21, s17, 10
  s_add_u32 s21, s21, 147456
  v_mfma_f32_16x16x32_bf16 v[128:131], v[80:83], v[68:71], v[128:131]
  v_add_u32_e64 v6, s21, v6
  v_lshlrev_b32 v7, 4, v2
  s_lshl_b32 s21, s18, 9
  s_add_u32 s21, s21, 149504
  v_mfma_f32_16x16x32_bf16 v[144:147], v[84:87], v[68:71], v[144:147]
  v_add_u32 v8, s21, v7
  s_lshl_b32 s21, s18, 6
  s_add_u32 s21, s21, 149888
  v_add_u32_e64 v9, s21, v7
  v_mfma_f32_16x16x32_bf16 v[160:163], v[88:91], v[68:71], v[160:163]
  s_lshl_b32 s21, s14, 1
  s_lshr_b32 s22, s15, 3
  s_add_u32 s21, s21, s22
  s_lshl_b32 s23, s21, 10
  v_mfma_f32_16x16x32_bf16 v[176:179], v[92:95], v[68:71], v[176:179]
  s_add_u32 s23, s23, 0x981000
  s_and_b32 s22, s15, 7
  s_lshl_b32 s22, s22, 2
  s_add_u32 s22, s22, s16
  v_mfma_f32_16x16x32_bf16 v[192:195], v[96:99], v[68:71], v[192:195]
  s_lshl_b32 s22, s22, 2
  s_add_u32 s23, s23, s22
  v_mov_b32 v220, s23
  s_mul_i32 s21, s21, 573440
  v_mfma_f32_16x16x32_bf16 v[208:211], v[100:103], v[68:71], v[208:211]
  s_add_u32 s21, s21, 0x1000000
  s_and_b32 s23, s15, 7
  v_lshlrev_b32 v10, 4, v1
  s_lshl_b32 s22, s23, 1
  s_waitcnt lgkmcnt(0)
  v_mfma_f32_16x16x32_bf16 v[116:119], v[76:79], v[72:75], v[116:119]
  s_add_u32 s22, s22, s18
  s_mul_i32 s22, s22, 10240
  s_add_u32 s59, s22, s21
  s_add_u32 s60, s59, 163840
  v_mfma_f32_16x16x32_bf16 v[132:135], v[80:83], v[72:75], v[132:135]
  s_add_u32 s61, s60, 163840
  s_add_u32 s22, s23, 48
  s_mul_i32 s22, s22, 10240
  s_add_u32 s62, s22, s21
  v_mfma_f32_16x16x32_bf16 v[148:151], v[84:87], v[72:75], v[148:151]
  s_lshl_b32 s21, s18, 14
  s_lshl_b32 s22, s17, 12
  s_add_u32 s21, s21, s22
  v_add_u32 v216, s21, v10
  v_mfma_f32_16x16x32_bf16 v[164:167], v[88:91], v[72:75], v[164:167]
  v_add_u32 v217, 65536, v216
  v_mov_b32 v222, 162860
  s_barrier
  ds_read_b128 v[16:19], v6 offset:0
  v_mfma_f32_16x16x32_bf16 v[180:183], v[92:95], v[72:75], v[180:183]
  ds_read_b128 v[20:23], v6 offset:256
  ds_read_b128 v[24:27], v6 offset:512
  ds_read_b128 v[28:31], v6 offset:768
  ds_read_b128 v[32:35], v8 offset:0
  v_mfma_f32_16x16x32_bf16 v[196:199], v[96:99], v[72:75], v[196:199]
  ds_read_b128 v[36:39], v8 offset:64
  ds_read_b128 v[40:43], v8 offset:128
  ds_read_b128 v[44:47], v8 offset:192
  v_mfma_f32_16x16x32_bf16 v[212:215], v[100:103], v[72:75], v[212:215]
  ds_read_b128 v[48:51], v8 offset:256
  ds_read_b128 v[52:55], v8 offset:320
  ds_read_b128 v[56:59], v9
  s_waitcnt lgkmcnt(0)
  v_pk_fma_f32 v[104:105], v[32:33], v[16:17], v[104:105] op_sel_hi:[1,0,1]
  v_pk_fma_f32 v[106:107], v[34:35], v[16:17], v[106:107] op_sel_hi:[1,0,1]
  v_pk_fma_f32 v[120:121], v[36:37], v[16:17], v[120:121] op_sel_hi:[1,0,1]
  v_pk_fma_f32 v[122:123], v[38:39], v[16:17], v[122:123] op_sel_hi:[1,0,1]
  v_pk_mul_f32 v[60:61], v[104:105], v[16:17] op_sel:[0,1] op_sel_hi:[1,1]
  v_pk_mul_f32 v[62:63], v[106:107], v[16:17] op_sel:[0,1] op_sel_hi:[1,1]
  v_pk_mul_f32 v[64:65], v[120:121], v[16:17] op_sel:[0,1] op_sel_hi:[1,1]
  v_pk_mul_f32 v[66:67], v[122:123], v[16:17] op_sel:[0,1] op_sel_hi:[1,1]
  v_exp_f32 v60, v60
  v_exp_f32 v61, v61
  v_exp_f32 v62, v62
  v_exp_f32 v63, v63
  v_exp_f32 v64, v64
  v_exp_f32 v65, v65
  v_exp_f32 v66, v66
  v_exp_f32 v67, v67
  v_pk_fma_f32 v[60:61], v[60:61], v[18:19], v[18:19]
  v_pk_fma_f32 v[62:63], v[62:63], v[18:19], v[18:19]
  v_pk_fma_f32 v[64:65], v[64:65], v[18:19], v[18:19]
  v_pk_fma_f32 v[66:67], v[66:67], v[18:19], v[18:19]
  v_rcp_f32 v60, v60
  v_rcp_f32 v61, v61
  v_rcp_f32 v62, v62
  v_rcp_f32 v63, v63
  v_rcp_f32 v64, v64
  v_rcp_f32 v65, v65
  v_rcp_f32 v66, v66
  v_rcp_f32 v67, v67
  v_pk_mul_f32 v[104:105], v[104:105], v[60:61]
  v_pk_mul_f32 v[106:107], v[106:107], v[62:63]
  v_pk_mul_f32 v[120:121], v[120:121], v[64:65]
  v_pk_mul_f32 v[122:123], v[122:123], v[66:67]
  v_cvt_pk_bf16_f32 v72, v104, v105
  v_cvt_pk_bf16_f32 v73, v106, v107
  v_cvt_pk_bf16_f32 v74, v120, v121
  v_cvt_pk_bf16_f32 v75, v122, v123
  ds_write_b128 v217, v[72:75] offset:0
  buffer_store_dwordx4 v[72:75], v224, s[44:47], s59 offen sc1
  v_pk_fma_f32 v[108:109], v[32:33], v[20:21], v[108:109] op_sel_hi:[1,0,1]
  v_pk_fma_f32 v[110:111], v[34:35], v[20:21], v[110:111] op_sel_hi:[1,0,1]
  v_pk_fma_f32 v[124:125], v[36:37], v[20:21], v[124:125] op_sel_hi:[1,0,1]
  v_pk_fma_f32 v[126:127], v[38:39], v[20:21], v[126:127] op_sel_hi:[1,0,1]
  v_pk_mul_f32 v[60:61], v[108:109], v[20:21] op_sel:[0,1] op_sel_hi:[1,1]
  v_pk_mul_f32 v[62:63], v[110:111], v[20:21] op_sel:[0,1] op_sel_hi:[1,1]
  v_pk_mul_f32 v[64:65], v[124:125], v[20:21] op_sel:[0,1] op_sel_hi:[1,1]
  v_pk_mul_f32 v[66:67], v[126:127], v[20:21] op_sel:[0,1] op_sel_hi:[1,1]
  v_exp_f32 v60, v60
  v_exp_f32 v61, v61
  v_exp_f32 v62, v62
  v_exp_f32 v63, v63
  v_exp_f32 v64, v64
  v_exp_f32 v65, v65
  v_exp_f32 v66, v66
  v_exp_f32 v67, v67
  v_pk_fma_f32 v[60:61], v[60:61], v[22:23], v[22:23]
  v_pk_fma_f32 v[62:63], v[62:63], v[22:23], v[22:23]
  v_pk_fma_f32 v[64:65], v[64:65], v[22:23], v[22:23]
  v_pk_fma_f32 v[66:67], v[66:67], v[22:23], v[22:23]
  v_rcp_f32 v60, v60
  v_rcp_f32 v61, v61
  v_rcp_f32 v62, v62
  v_rcp_f32 v63, v63
  v_rcp_f32 v64, v64
  v_rcp_f32 v65, v65
  v_rcp_f32 v66, v66
  v_rcp_f32 v67, v67
  v_pk_mul_f32 v[108:109], v[108:109], v[60:61]
  v_pk_mul_f32 v[110:111], v[110:111], v[62:63]
  v_pk_mul_f32 v[124:125], v[124:125], v[64:65]
  v_pk_mul_f32 v[126:127], v[126:127], v[66:67]
  v_cvt_pk_bf16_f32 v76, v108, v109
  v_cvt_pk_bf16_f32 v77, v110, v111
  v_cvt_pk_bf16_f32 v78, v124, v125
  v_cvt_pk_bf16_f32 v79, v126, v127
  ds_write_b128 v217, v[76:79] offset:1024
  buffer_store_dwordx4 v[76:79], v225, s[44:47], s59 offen sc1
  v_pk_fma_f32 v[112:113], v[32:33], v[24:25], v[112:113] op_sel_hi:[1,0,1]
  v_pk_fma_f32 v[114:115], v[34:35], v[24:25], v[114:115] op_sel_hi:[1,0,1]
  v_pk_fma_f32 v[128:129], v[36:37], v[24:25], v[128:129] op_sel_hi:[1,0,1]
  v_pk_fma_f32 v[130:131], v[38:39], v[24:25], v[130:131] op_sel_hi:[1,0,1]
  v_pk_mul_f32 v[60:61], v[112:113], v[24:25] op_sel:[0,1] op_sel_hi:[1,1]
  v_pk_mul_f32 v[62:63], v[114:115], v[24:25] op_sel:[0,1] op_sel_hi:[1,1]
  v_pk_mul_f32 v[64:65], v[128:129], v[24:25] op_sel:[0,1] op_sel_hi:[1,1]
  v_pk_mul_f32 v[66:67], v[130:131], v[24:25] op_sel:[0,1] op_sel_hi:[1,1]
  v_exp_f32 v60, v60
  v_exp_f32 v61, v61
  v_exp_f32 v62, v62
  v_exp_f32 v63, v63
  v_exp_f32 v64, v64
  v_exp_f32 v65, v65
  v_exp_f32 v66, v66
  v_exp_f32 v67, v67
  v_pk_fma_f32 v[60:61], v[60:61], v[26:27], v[26:27]
  v_pk_fma_f32 v[62:63], v[62:63], v[26:27], v[26:27]
  v_pk_fma_f32 v[64:65], v[64:65], v[26:27], v[26:27]
  v_pk_fma_f32 v[66:67], v[66:67], v[26:27], v[26:27]
  v_rcp_f32 v60, v60
  v_rcp_f32 v61, v61
  v_rcp_f32 v62, v62
  v_rcp_f32 v63, v63
  v_rcp_f32 v64, v64
  v_rcp_f32 v65, v65
  v_rcp_f32 v66, v66
  v_rcp_f32 v67, v67
  v_pk_mul_f32 v[112:113], v[112:113], v[60:61]
  v_pk_mul_f32 v[114:115], v[114:115], v[62:63]
  v_pk_mul_f32 v[128:129], v[128:129], v[64:65]
  v_pk_mul_f32 v[130:131], v[130:131], v[66:67]
  v_cvt_pk_bf16_f32 v80, v112, v113
  v_cvt_pk_bf16_f32 v81, v114, v115
  v_cvt_pk_bf16_f32 v82, v128, v129
  v_cvt_pk_bf16_f32 v83, v130, v131
  ds_write_b128 v217, v[80:83] offset:2048
  buffer_store_dwordx4 v[80:83], v226, s[44:47], s59 offen sc1
  v_pk_fma_f32 v[116:117], v[32:33], v[28:29], v[116:117] op_sel_hi:[1,0,1]
  v_pk_fma_f32 v[118:119], v[34:35], v[28:29], v[118:119] op_sel_hi:[1,0,1]
  v_pk_fma_f32 v[132:133], v[36:37], v[28:29], v[132:133] op_sel_hi:[1,0,1]
  v_pk_fma_f32 v[134:135], v[38:39], v[28:29], v[134:135] op_sel_hi:[1,0,1]
  v_pk_mul_f32 v[60:61], v[116:117], v[28:29] op_sel:[0,1] op_sel_hi:[1,1]
  v_pk_mul_f32 v[62:63], v[118:119], v[28:29] op_sel:[0,1] op_sel_hi:[1,1]
  v_pk_mul_f32 v[64:65], v[132:133], v[28:29] op_sel:[0,1] op_sel_hi:[1,1]
  v_pk_mul_f32 v[66:67], v[134:135], v[28:29] op_sel:[0,1] op_sel_hi:[1,1]
  v_exp_f32 v60, v60
  v_exp_f32 v61, v61
  v_exp_f32 v62, v62
  v_exp_f32 v63, v63
  v_exp_f32 v64, v64
  v_exp_f32 v65, v65
  v_exp_f32 v66, v66
  v_exp_f32 v67, v67
  v_pk_fma_f32 v[60:61], v[60:61], v[30:31], v[30:31]
  v_pk_fma_f32 v[62:63], v[62:63], v[30:31], v[30:31]
  v_pk_fma_f32 v[64:65], v[64:65], v[30:31], v[30:31]
  v_pk_fma_f32 v[66:67], v[66:67], v[30:31], v[30:31]
  v_rcp_f32 v60, v60
  v_rcp_f32 v61, v61
  v_rcp_f32 v62, v62
  v_rcp_f32 v63, v63
  v_rcp_f32 v64, v64
  v_rcp_f32 v65, v65
  v_rcp_f32 v66, v66
  v_rcp_f32 v67, v67
  v_pk_mul_f32 v[116:117], v[116:117], v[60:61]
  v_pk_mul_f32 v[118:119], v[118:119], v[62:63]
  v_pk_mul_f32 v[132:133], v[132:133], v[64:65]
  v_pk_mul_f32 v[134:135], v[134:135], v[66:67]
  v_cvt_pk_bf16_f32 v84, v116, v117
  v_cvt_pk_bf16_f32 v85, v118, v119
  v_cvt_pk_bf16_f32 v86, v132, v133
  v_cvt_pk_bf16_f32 v87, v134, v135
  ds_write_b128 v217, v[84:87] offset:3072
  buffer_store_dwordx4 v[84:87], v227, s[44:47], s59 offen sc1
  v_pk_fma_f32 v[136:137], v[40:41], v[16:17], v[136:137] op_sel_hi:[1,0,1]
  v_pk_fma_f32 v[138:139], v[42:43], v[16:17], v[138:139] op_sel_hi:[1,0,1]
  v_pk_fma_f32 v[152:153], v[44:45], v[16:17], v[152:153] op_sel_hi:[1,0,1]
  v_pk_fma_f32 v[154:155], v[46:47], v[16:17], v[154:155] op_sel_hi:[1,0,1]
  v_pk_mul_f32 v[60:61], v[136:137], v[16:17] op_sel:[0,1] op_sel_hi:[1,1]
  v_pk_mul_f32 v[62:63], v[138:139], v[16:17] op_sel:[0,1] op_sel_hi:[1,1]
  v_pk_mul_f32 v[64:65], v[152:153], v[16:17] op_sel:[0,1] op_sel_hi:[1,1]
  v_pk_mul_f32 v[66:67], v[154:155], v[16:17] op_sel:[0,1] op_sel_hi:[1,1]
  v_exp_f32 v60, v60
  v_exp_f32 v61, v61
  v_exp_f32 v62, v62
  v_exp_f32 v63, v63
  v_exp_f32 v64, v64
  v_exp_f32 v65, v65
  v_exp_f32 v66, v66
  v_exp_f32 v67, v67
  v_pk_fma_f32 v[60:61], v[60:61], v[18:19], v[18:19]
  v_pk_fma_f32 v[62:63], v[62:63], v[18:19], v[18:19]
  v_pk_fma_f32 v[64:65], v[64:65], v[18:19], v[18:19]
  v_pk_fma_f32 v[66:67], v[66:67], v[18:19], v[18:19]
  v_rcp_f32 v60, v60
  v_rcp_f32 v61, v61
  v_rcp_f32 v62, v62
  v_rcp_f32 v63, v63
  v_rcp_f32 v64, v64
  v_rcp_f32 v65, v65
  v_rcp_f32 v66, v66
  v_rcp_f32 v67, v67
  v_pk_mul_f32 v[136:137], v[136:137], v[60:61]
  v_pk_mul_f32 v[138:139], v[138:139], v[62:63]
  v_pk_mul_f32 v[152:153], v[152:153], v[64:65]
  v_pk_mul_f32 v[154:155], v[154:155], v[66:67]
  v_cvt_pk_bf16_f32 v88, v136, v137
  v_cvt_pk_bf16_f32 v89, v138, v139
  v_cvt_pk_bf16_f32 v90, v152, v153
  v_cvt_pk_bf16_f32 v91, v154, v155
  ds_write_b128 v217, v[88:91] offset:32768
  v_pk_fma_f32 v[140:141], v[40:41], v[20:21], v[140:141] op_sel_hi:[1,0,1]
  v_pk_fma_f32 v[142:143], v[42:43], v[20:21], v[142:143] op_sel_hi:[1,0,1]
  v_pk_fma_f32 v[156:157], v[44:45], v[20:21], v[156:157] op_sel_hi:[1,0,1]
  v_pk_fma_f32 v[158:159], v[46:47], v[20:21], v[158:159] op_sel_hi:[1,0,1]
  v_pk_mul_f32 v[60:61], v[140:141], v[20:21] op_sel:[0,1] op_sel_hi:[1,1]
  v_pk_mul_f32 v[62:63], v[142:143], v[20:21] op_sel:[0,1] op_sel_hi:[1,1]
  v_pk_mul_f32 v[64:65], v[156:157], v[20:21] op_sel:[0,1] op_sel_hi:[1,1]
  v_pk_mul_f32 v[66:67], v[158:159], v[20:21] op_sel:[0,1] op_sel_hi:[1,1]
  v_exp_f32 v60, v60
  v_exp_f32 v61, v61
  v_exp_f32 v62, v62
  v_exp_f32 v63, v63
  v_exp_f32 v64, v64
  v_exp_f32 v65, v65
  v_exp_f32 v66, v66
  v_exp_f32 v67, v67
  v_pk_fma_f32 v[60:61], v[60:61], v[22:23], v[22:23]
  v_pk_fma_f32 v[62:63], v[62:63], v[22:23], v[22:23]
  v_pk_fma_f32 v[64:65], v[64:65], v[22:23], v[22:23]
  v_pk_fma_f32 v[66:67], v[66:67], v[22:23], v[22:23]
  v_rcp_f32 v60, v60
  v_rcp_f32 v61, v61
  v_rcp_f32 v62, v62
  v_rcp_f32 v63, v63
  v_rcp_f32 v64, v64
  v_rcp_f32 v65, v65
  v_rcp_f32 v66, v66
  v_rcp_f32 v67, v67
  v_pk_mul_f32 v[140:141], v[140:141], v[60:61]
  v_pk_mul_f32 v[142:143], v[142:143], v[62:63]
  v_pk_mul_f32 v[156:157], v[156:157], v[64:65]
  v_pk_mul_f32 v[158:159], v[158:159], v[66:67]
  v_cvt_pk_bf16_f32 v92, v140, v141
  v_cvt_pk_bf16_f32 v93, v142, v143
  v_cvt_pk_bf16_f32 v94, v156, v157
  v_cvt_pk_bf16_f32 v95, v158, v159
  ds_write_b128 v217, v[92:95] offset:33792
  v_pk_fma_f32 v[144:145], v[40:41], v[24:25], v[144:145] op_sel_hi:[1,0,1]
  v_pk_fma_f32 v[146:147], v[42:43], v[24:25], v[146:147] op_sel_hi:[1,0,1]
  v_pk_fma_f32 v[160:161], v[44:45], v[24:25], v[160:161] op_sel_hi:[1,0,1]
  v_pk_fma_f32 v[162:163], v[46:47], v[24:25], v[162:163] op_sel_hi:[1,0,1]
  v_pk_mul_f32 v[60:61], v[144:145], v[24:25] op_sel:[0,1] op_sel_hi:[1,1]
  v_pk_mul_f32 v[62:63], v[146:147], v[24:25] op_sel:[0,1] op_sel_hi:[1,1]
  v_pk_mul_f32 v[64:65], v[160:161], v[24:25] op_sel:[0,1] op_sel_hi:[1,1]
  v_pk_mul_f32 v[66:67], v[162:163], v[24:25] op_sel:[0,1] op_sel_hi:[1,1]
  v_exp_f32 v60, v60
  v_exp_f32 v61, v61
  v_exp_f32 v62, v62
  v_exp_f32 v63, v63
  v_exp_f32 v64, v64
  v_exp_f32 v65, v65
  v_exp_f32 v66, v66
  v_exp_f32 v67, v67
  v_pk_fma_f32 v[60:61], v[60:61], v[26:27], v[26:27]
  v_pk_fma_f32 v[62:63], v[62:63], v[26:27], v[26:27]
  v_pk_fma_f32 v[64:65], v[64:65], v[26:27], v[26:27]
  v_pk_fma_f32 v[66:67], v[66:67], v[26:27], v[26:27]
  v_rcp_f32 v60, v60
  v_rcp_f32 v61, v61
  v_rcp_f32 v62, v62
  v_rcp_f32 v63, v63
  v_rcp_f32 v64, v64
  v_rcp_f32 v65, v65
  v_rcp_f32 v66, v66
  v_rcp_f32 v67, v67
  v_pk_mul_f32 v[144:145], v[144:145], v[60:61]
  v_pk_mul_f32 v[146:147], v[146:147], v[62:63]
  v_pk_mul_f32 v[160:161], v[160:161], v[64:65]
  v_pk_mul_f32 v[162:163], v[162:163], v[66:67]
  v_cvt_pk_bf16_f32 v96, v144, v145
  v_cvt_pk_bf16_f32 v97, v146, v147
  v_cvt_pk_bf16_f32 v98, v160, v161
  v_cvt_pk_bf16_f32 v99, v162, v163
  ds_write_b128 v217, v[96:99] offset:34816
  v_pk_fma_f32 v[148:149], v[40:41], v[28:29], v[148:149] op_sel_hi:[1,0,1]
  v_pk_fma_f32 v[150:151], v[42:43], v[28:29], v[150:151] op_sel_hi:[1,0,1]
  v_pk_fma_f32 v[164:165], v[44:45], v[28:29], v[164:165] op_sel_hi:[1,0,1]
  v_pk_fma_f32 v[166:167], v[46:47], v[28:29], v[166:167] op_sel_hi:[1,0,1]
  v_pk_mul_f32 v[60:61], v[148:149], v[28:29] op_sel:[0,1] op_sel_hi:[1,1]
  v_pk_mul_f32 v[62:63], v[150:151], v[28:29] op_sel:[0,1] op_sel_hi:[1,1]
  v_pk_mul_f32 v[64:65], v[164:165], v[28:29] op_sel:[0,1] op_sel_hi:[1,1]
  v_pk_mul_f32 v[66:67], v[166:167], v[28:29] op_sel:[0,1] op_sel_hi:[1,1]
  v_exp_f32 v60, v60
  v_exp_f32 v61, v61
  v_exp_f32 v62, v62
  v_exp_f32 v63, v63
  v_exp_f32 v64, v64
  v_exp_f32 v65, v65
  v_exp_f32 v66, v66
  v_exp_f32 v67, v67
  v_pk_fma_f32 v[60:61], v[60:61], v[30:31], v[30:31]
  v_pk_fma_f32 v[62:63], v[62:63], v[30:31], v[30:31]
  v_pk_fma_f32 v[64:65], v[64:65], v[30:31], v[30:31]
  v_pk_fma_f32 v[66:67], v[66:67], v[30:31], v[30:31]
  v_rcp_f32 v60, v60
  v_rcp_f32 v61, v61
  v_rcp_f32 v62, v62
  v_rcp_f32 v63, v63
  v_rcp_f32 v64, v64
  v_rcp_f32 v65, v65
  v_rcp_f32 v66, v66
  v_rcp_f32 v67, v67
  v_pk_mul_f32 v[148:149], v[148:149], v[60:61]
  v_pk_mul_f32 v[150:151], v[150:151], v[62:63]
  v_pk_mul_f32 v[164:165], v[164:165], v[64:65]
  v_pk_mul_f32 v[166:167], v[166:167], v[66:67]
  v_cvt_pk_bf16_f32 v100, v148, v149
  v_cvt_pk_bf16_f32 v101, v150, v151
  v_cvt_pk_bf16_f32 v102, v164, v165
  v_cvt_pk_bf16_f32 v103, v166, v167
  ds_write_b128 v217, v[100:103] offset:35840
  s_waitcnt vmcnt(0)
  s_mov_b64 exec, 1
  buffer_store_dword v221, v220, s[44:47], 0 offen offset:0 sc1
  s_mov_b64 exec, -1
  buffer_store_dwordx4 v[88:91], v224, s[44:47], s60 offen sc1
  buffer_store_dwordx4 v[92:95], v225, s[44:47], s60 offen sc1
  buffer_store_dwordx4 v[96:99], v226, s[44:47], s60 offen sc1
  buffer_store_dwordx4 v[100:103], v227, s[44:47], s60 offen sc1
  s_nop 0
  v_pk_fma_f32 v[168:169], v[48:49], v[16:17], v[168:169] op_sel_hi:[1,0,1]
  v_pk_fma_f32 v[170:171], v[50:51], v[16:17], v[170:171] op_sel_hi:[1,0,1]
  v_pk_fma_f32 v[184:185], v[52:53], v[16:17], v[184:185] op_sel_hi:[1,0,1]
  v_pk_fma_f32 v[186:187], v[54:55], v[16:17], v[186:187] op_sel_hi:[1,0,1]
  v_pk_mul_f32 v[60:61], v[168:169], v[16:17] op_sel:[0,1] op_sel_hi:[1,1]
  v_pk_mul_f32 v[62:63], v[170:171], v[16:17] op_sel:[0,1] op_sel_hi:[1,1]
  v_pk_mul_f32 v[64:65], v[184:185], v[16:17] op_sel:[0,1] op_sel_hi:[1,1]
  v_pk_mul_f32 v[66:67], v[186:187], v[16:17] op_sel:[0,1] op_sel_hi:[1,1]
  v_exp_f32 v60, v60
  v_exp_f32 v61, v61
  v_exp_f32 v62, v62
  v_exp_f32 v63, v63
  v_exp_f32 v64, v64
  v_exp_f32 v65, v65
  v_exp_f32 v66, v66
  v_exp_f32 v67, v67
  v_pk_fma_f32 v[60:61], v[60:61], v[18:19], v[18:19]
  v_pk_fma_f32 v[62:63], v[62:63], v[18:19], v[18:19]
  v_pk_fma_f32 v[64:65], v[64:65], v[18:19], v[18:19]
  v_pk_fma_f32 v[66:67], v[66:67], v[18:19], v[18:19]
  v_rcp_f32 v60, v60
  v_rcp_f32 v61, v61
  v_rcp_f32 v62, v62
  v_rcp_f32 v63, v63
  v_rcp_f32 v64, v64
  v_rcp_f32 v65, v65
  v_rcp_f32 v66, v66
  v_rcp_f32 v67, v67
  v_pk_mul_f32 v[168:169], v[168:169], v[60:61]
  v_pk_mul_f32 v[170:171], v[170:171], v[62:63]
  v_pk_mul_f32 v[184:185], v[184:185], v[64:65]
  v_pk_mul_f32 v[186:187], v[186:187], v[66:67]
  v_cvt_pk_bf16_f32 v104, v168, v169
  v_cvt_pk_bf16_f32 v105, v170, v171
  v_cvt_pk_bf16_f32 v106, v184, v185
  v_cvt_pk_bf16_f32 v107, v186, v187
  ds_write_b128 v216, v[104:107] offset:0
  buffer_store_dwordx4 v[104:107], v224, s[44:47], s61 offen sc1
  v_pk_fma_f32 v[172:173], v[48:49], v[20:21], v[172:173] op_sel_hi:[1,0,1]
  v_pk_fma_f32 v[174:175], v[50:51], v[20:21], v[174:175] op_sel_hi:[1,0,1]
  v_pk_fma_f32 v[188:189], v[52:53], v[20:21], v[188:189] op_sel_hi:[1,0,1]
  v_pk_fma_f32 v[190:191], v[54:55], v[20:21], v[190:191] op_sel_hi:[1,0,1]
  v_pk_mul_f32 v[60:61], v[172:173], v[20:21] op_sel:[0,1] op_sel_hi:[1,1]
  v_pk_mul_f32 v[62:63], v[174:175], v[20:21] op_sel:[0,1] op_sel_hi:[1,1]
  v_pk_mul_f32 v[64:65], v[188:189], v[20:21] op_sel:[0,1] op_sel_hi:[1,1]
  v_pk_mul_f32 v[66:67], v[190:191], v[20:21] op_sel:[0,1] op_sel_hi:[1,1]
  v_exp_f32 v60, v60
  v_exp_f32 v61, v61
  v_exp_f32 v62, v62
  v_exp_f32 v63, v63
  v_exp_f32 v64, v64
  v_exp_f32 v65, v65
  v_exp_f32 v66, v66
  v_exp_f32 v67, v67
  v_pk_fma_f32 v[60:61], v[60:61], v[22:23], v[22:23]
  v_pk_fma_f32 v[62:63], v[62:63], v[22:23], v[22:23]
  v_pk_fma_f32 v[64:65], v[64:65], v[22:23], v[22:23]
  v_pk_fma_f32 v[66:67], v[66:67], v[22:23], v[22:23]
  v_rcp_f32 v60, v60
  v_rcp_f32 v61, v61
  v_rcp_f32 v62, v62
  v_rcp_f32 v63, v63
  v_rcp_f32 v64, v64
  v_rcp_f32 v65, v65
  v_rcp_f32 v66, v66
  v_rcp_f32 v67, v67
  v_pk_mul_f32 v[172:173], v[172:173], v[60:61]
  v_pk_mul_f32 v[174:175], v[174:175], v[62:63]
  v_pk_mul_f32 v[188:189], v[188:189], v[64:65]
  v_pk_mul_f32 v[190:191], v[190:191], v[66:67]
  v_cvt_pk_bf16_f32 v108, v172, v173
  v_cvt_pk_bf16_f32 v109, v174, v175
  v_cvt_pk_bf16_f32 v110, v188, v189
  v_cvt_pk_bf16_f32 v111, v190, v191
  ds_write_b128 v216, v[108:111] offset:1024
  s_mov_b64 exec, 1
  ds_add_u32 v222, v221
  s_mov_b64 exec, -1
  buffer_store_dwordx4 v[108:111], v225, s[44:47], s61 offen sc1
  v_pk_fma_f32 v[176:177], v[48:49], v[24:25], v[176:177] op_sel_hi:[1,0,1]
  v_pk_fma_f32 v[178:179], v[50:51], v[24:25], v[178:179] op_sel_hi:[1,0,1]
  v_pk_fma_f32 v[192:193], v[52:53], v[24:25], v[192:193] op_sel_hi:[1,0,1]
  v_pk_fma_f32 v[194:195], v[54:55], v[24:25], v[194:195] op_sel_hi:[1,0,1]
  v_pk_mul_f32 v[60:61], v[176:177], v[24:25] op_sel:[0,1] op_sel_hi:[1,1]
  v_pk_mul_f32 v[62:63], v[178:179], v[24:25] op_sel:[0,1] op_sel_hi:[1,1]
  v_pk_mul_f32 v[64:65], v[192:193], v[24:25] op_sel:[0,1] op_sel_hi:[1,1]
  v_pk_mul_f32 v[66:67], v[194:195], v[24:25] op_sel:[0,1] op_sel_hi:[1,1]
  v_exp_f32 v60, v60
  v_exp_f32 v61, v61
  v_exp_f32 v62, v62
  v_exp_f32 v63, v63
  v_exp_f32 v64, v64
  v_exp_f32 v65, v65
  v_exp_f32 v66, v66
  v_exp_f32 v67, v67
  v_pk_fma_f32 v[60:61], v[60:61], v[26:27], v[26:27]
  v_pk_fma_f32 v[62:63], v[62:63], v[26:27], v[26:27]
  v_pk_fma_f32 v[64:65], v[64:65], v[26:27], v[26:27]
  v_pk_fma_f32 v[66:67], v[66:67], v[26:27], v[26:27]
  v_rcp_f32 v60, v60
  v_rcp_f32 v61, v61
  v_rcp_f32 v62, v62
  v_rcp_f32 v63, v63
  v_rcp_f32 v64, v64
  v_rcp_f32 v65, v65
  v_rcp_f32 v66, v66
  v_rcp_f32 v67, v67
  v_pk_mul_f32 v[176:177], v[176:177], v[60:61]
  v_pk_mul_f32 v[178:179], v[178:179], v[62:63]
  v_pk_mul_f32 v[192:193], v[192:193], v[64:65]
  v_pk_mul_f32 v[194:195], v[194:195], v[66:67]
  v_cvt_pk_bf16_f32 v112, v176, v177
  v_cvt_pk_bf16_f32 v113, v178, v179
  v_cvt_pk_bf16_f32 v114, v192, v193
  v_cvt_pk_bf16_f32 v115, v194, v195
  ds_write_b128 v216, v[112:115] offset:2048
  buffer_store_dwordx4 v[112:115], v226, s[44:47], s61 offen sc1
  v_pk_fma_f32 v[180:181], v[48:49], v[28:29], v[180:181] op_sel_hi:[1,0,1]
  v_pk_fma_f32 v[182:183], v[50:51], v[28:29], v[182:183] op_sel_hi:[1,0,1]
  v_pk_fma_f32 v[196:197], v[52:53], v[28:29], v[196:197] op_sel_hi:[1,0,1]
  v_pk_fma_f32 v[198:199], v[54:55], v[28:29], v[198:199] op_sel_hi:[1,0,1]
  v_pk_mul_f32 v[60:61], v[180:181], v[28:29] op_sel:[0,1] op_sel_hi:[1,1]
  v_pk_mul_f32 v[62:63], v[182:183], v[28:29] op_sel:[0,1] op_sel_hi:[1,1]
  v_pk_mul_f32 v[64:65], v[196:197], v[28:29] op_sel:[0,1] op_sel_hi:[1,1]
  v_pk_mul_f32 v[66:67], v[198:199], v[28:29] op_sel:[0,1] op_sel_hi:[1,1]
  v_exp_f32 v60, v60
  v_exp_f32 v61, v61
  v_exp_f32 v62, v62
  v_exp_f32 v63, v63
  v_exp_f32 v64, v64
  v_exp_f32 v65, v65
  v_exp_f32 v66, v66
  v_exp_f32 v67, v67
  v_pk_fma_f32 v[60:61], v[60:61], v[30:31], v[30:31]
  v_pk_fma_f32 v[62:63], v[62:63], v[30:31], v[30:31]
  v_pk_fma_f32 v[64:65], v[64:65], v[30:31], v[30:31]
  v_pk_fma_f32 v[66:67], v[66:67], v[30:31], v[30:31]
  v_rcp_f32 v60, v60
  v_rcp_f32 v61, v61
  v_rcp_f32 v62, v62
  v_rcp_f32 v63, v63
  v_rcp_f32 v64, v64
  v_rcp_f32 v65, v65
  v_rcp_f32 v66, v66
  v_rcp_f32 v67, v67
  v_pk_mul_f32 v[180:181], v[180:181], v[60:61]
  v_pk_mul_f32 v[182:183], v[182:183], v[62:63]
  v_pk_mul_f32 v[196:197], v[196:197], v[64:65]
  v_pk_mul_f32 v[198:199], v[198:199], v[66:67]
  v_cvt_pk_bf16_f32 v116, v180, v181
  v_cvt_pk_bf16_f32 v117, v182, v183
  v_cvt_pk_bf16_f32 v118, v196, v197
  v_cvt_pk_bf16_f32 v119, v198, v199
  ds_write_b128 v216, v[116:119] offset:3072
  buffer_store_dwordx4 v[116:119], v227, s[44:47], s61 offen sc1
  v_pk_fma_f32 v[200:201], v[56:57], v[16:17], v[200:201] op_sel_hi:[1,0,1]
  v_pk_fma_f32 v[202:203], v[58:59], v[16:17], v[202:203] op_sel_hi:[1,0,1]
  v_pk_fma_f32 v[204:205], v[56:57], v[20:21], v[204:205] op_sel_hi:[1,0,1]
  v_pk_fma_f32 v[206:207], v[58:59], v[20:21], v[206:207] op_sel_hi:[1,0,1]
  v_pk_mul_f32 v[60:61], v[200:201], v[16:17] op_sel:[0,1] op_sel_hi:[1,1]
  v_pk_mul_f32 v[62:63], v[202:203], v[16:17] op_sel:[0,1] op_sel_hi:[1,1]
  v_pk_mul_f32 v[64:65], v[204:205], v[20:21] op_sel:[0,1] op_sel_hi:[1,1]
  v_pk_mul_f32 v[66:67], v[206:207], v[20:21] op_sel:[0,1] op_sel_hi:[1,1]
  v_exp_f32 v60, v60
  v_exp_f32 v61, v61
  v_exp_f32 v62, v62
  v_exp_f32 v63, v63
  v_exp_f32 v64, v64
  v_exp_f32 v65, v65
  v_exp_f32 v66, v66
  v_exp_f32 v67, v67
  v_pk_fma_f32 v[60:61], v[60:61], v[18:19], v[18:19]
  v_pk_fma_f32 v[62:63], v[62:63], v[18:19], v[18:19]
  v_pk_fma_f32 v[64:65], v[64:65], v[22:23], v[22:23]
  v_pk_fma_f32 v[66:67], v[66:67], v[22:23], v[22:23]
  v_rcp_f32 v60, v60
  v_rcp_f32 v61, v61
  v_rcp_f32 v62, v62
  v_rcp_f32 v63, v63
  v_rcp_f32 v64, v64
  v_rcp_f32 v65, v65
  v_rcp_f32 v66, v66
  v_rcp_f32 v67, v67
  v_pk_mul_f32 v[200:201], v[200:201], v[60:61]
  v_pk_mul_f32 v[202:203], v[202:203], v[62:63]
  v_pk_mul_f32 v[204:205], v[204:205], v[64:65]
  v_pk_mul_f32 v[206:207], v[206:207], v[66:67]
  v_cvt_pk_bf16_f32 v120, v200, v201
  v_cvt_pk_bf16_f32 v121, v202, v203
  v_cvt_pk_bf16_f32 v122, v204, v205
  v_cvt_pk_bf16_f32 v123, v206, v207
  s_nop 1
  v_permlane16_swap_b32 v120, v122
  v_permlane16_swap_b32 v121, v123
  buffer_store_dwordx4 v[120:123], v228, s[44:47], s62 offen sc1
  s_nop 0
  v_pk_fma_f32 v[208:209], v[56:57], v[24:25], v[208:209] op_sel_hi:[1,0,1]
  v_pk_fma_f32 v[210:211], v[58:59], v[24:25], v[210:211] op_sel_hi:[1,0,1]
  v_pk_fma_f32 v[212:213], v[56:57], v[28:29], v[212:213] op_sel_hi:[1,0,1]
  v_pk_fma_f32 v[214:215], v[58:59], v[28:29], v[214:215] op_sel_hi:[1,0,1]
  v_pk_mul_f32 v[60:61], v[208:209], v[24:25] op_sel:[0,1] op_sel_hi:[1,1]
  v_pk_mul_f32 v[62:63], v[210:211], v[24:25] op_sel:[0,1] op_sel_hi:[1,1]
  v_pk_mul_f32 v[64:65], v[212:213], v[28:29] op_sel:[0,1] op_sel_hi:[1,1]
  v_pk_mul_f32 v[66:67], v[214:215], v[28:29] op_sel:[0,1] op_sel_hi:[1,1]
  v_exp_f32 v60, v60
  v_exp_f32 v61, v61
  v_exp_f32 v62, v62
  v_exp_f32 v63, v63
  v_exp_f32 v64, v64
  v_exp_f32 v65, v65
  v_exp_f32 v66, v66
  v_exp_f32 v67, v67
  v_pk_fma_f32 v[60:61], v[60:61], v[26:27], v[26:27]
  v_pk_fma_f32 v[62:63], v[62:63], v[26:27], v[26:27]
  v_pk_fma_f32 v[64:65], v[64:65], v[30:31], v[30:31]
  v_pk_fma_f32 v[66:67], v[66:67], v[30:31], v[30:31]
  v_rcp_f32 v60, v60
  v_rcp_f32 v61, v61
  v_rcp_f32 v62, v62
  v_rcp_f32 v63, v63
  v_rcp_f32 v64, v64
  v_rcp_f32 v65, v65
  v_rcp_f32 v66, v66
  v_rcp_f32 v67, v67
  v_pk_mul_f32 v[208:209], v[208:209], v[60:61]
  v_pk_mul_f32 v[210:211], v[210:211], v[62:63]
  v_pk_mul_f32 v[212:213], v[212:213], v[64:65]
  v_pk_mul_f32 v[214:215], v[214:215], v[66:67]
  v_cvt_pk_bf16_f32 v124, v208, v209
  v_cvt_pk_bf16_f32 v125, v210, v211
  v_cvt_pk_bf16_f32 v126, v212, v213
  v_cvt_pk_bf16_f32 v127, v214, v215
  s_nop 1
  v_permlane16_swap_b32 v124, v126
  v_permlane16_swap_b32 v125, v127
  buffer_store_dwordx4 v[124:127], v229, s[44:47], s62 offen sc1
  s_lshr_b32 s19, s15, 3
  s_and_b32 s15, s15, 7
  s_mov_b32 s30, 32768
  s_mov_b32 s31, 4294868992
  v_lshlrev_b32 v8, 4, v1
  s_lshl_b32 s21, s17, 12
  s_add_u32 s21, s21, 65536
  v_add_u32 v8, s21, v8
  v_lshlrev_b32 v6, 2, v2
  v_add_u32 v6, v6, v3
  v_and_b32 v7, 7, v6
  v_lshlrev_b32 v13, 3, v4
  v_lshl_add_u32 v6, v6, 8, v13
  v_lshl_add_u32 v14, v7, 5, v6
  s_lshl_b32 s21, s18, 6
  s_lshl_b32 s22, s19, 7
  s_add_u32 s21, s21, s22
  v_xor_b32 v9, s21, v14
  v_add_u32 v9, 73728, v9
  v_xor_b32_e64 v10, 32, v9
  v_xor_b32 v11, 128, v9
  v_xor_b32 v12, 160, v9
  s_waitcnt lgkmcnt(0)
  s_barrier
  s_mov_b32 s34, 2
  s_mov_b32 s32, 1
  s_mov_b32 s36, 99
  ds_read_b128 v[16:19], v8 offset:0
  ds_read_b64_tr_b16 v[32:33], v9 offset:0
  ds_read_b64_tr_b16 v[34:35], v9 offset:4096
  ds_read_b64_tr_b16 v[36:37], v10 offset:0
  ds_read_b64_tr_b16 v[38:39], v10 offset:4096
  ds_read_b64_tr_b16 v[40:41], v11 offset:0
  ds_read_b64_tr_b16 v[42:43], v11 offset:4096
  ds_read_b64_tr_b16 v[44:45], v12 offset:0
  ds_read_b64_tr_b16 v[46:47], v12 offset:4096
  ds_read_b128 v[20:23], v8 offset:1024
  ds_read_b128 v[24:27], v8 offset:2048
  ds_read_b128 v[28:31], v8 offset:3072
  s_waitcnt lgkmcnt(9)
  v_mfma_f32_16x16x32_bf16 v[80:83], v[32:35], v[16:19], 0
  ds_read_b128 v[48:51], v8 offset:16384
  s_waitcnt lgkmcnt(8)
  v_mfma_f32_16x16x32_bf16 v[96:99], v[36:39], v[16:19], 0
  ds_read_b64_tr_b16 v[64:65], v9 offset:16384
  s_waitcnt lgkmcnt(7)
  v_mfma_f32_16x16x32_bf16 v[112:115], v[40:43], v[16:19], 0
  ds_read_b64_tr_b16 v[66:67], v9 offset:20480
  s_waitcnt lgkmcnt(6)
  v_mfma_f32_16x16x32_bf16 v[128:131], v[44:47], v[16:19], 0
  ds_read_b64_tr_b16 v[68:69], v10 offset:16384
  s_waitcnt lgkmcnt(6)
  v_mfma_f32_16x16x32_bf16 v[84:87], v[32:35], v[20:23], 0
  ds_read_b64_tr_b16 v[70:71], v10 offset:20480
  v_mfma_f32_16x16x32_bf16 v[100:103], v[36:39], v[20:23], 0
  ds_read_b64_tr_b16 v[72:73], v11 offset:16384
  v_mfma_f32_16x16x32_bf16 v[116:119], v[40:43], v[20:23], 0
  ds_read_b64_tr_b16 v[74:75], v11 offset:20480
  v_mfma_f32_16x16x32_bf16 v[132:135], v[44:47], v[20:23], 0
  ds_read_b64_tr_b16 v[76:77], v12 offset:16384
  s_waitcnt lgkmcnt(9)
  v_mfma_f32_16x16x32_bf16 v[88:91], v[32:35], v[24:27], 0
  ds_read_b64_tr_b16 v[78:79], v12 offset:20480
  v_mfma_f32_16x16x32_bf16 v[104:107], v[36:39], v[24:27], 0
  ds_read_b128 v[52:55], v8 offset:17408
  v_mfma_f32_16x16x32_bf16 v[120:123], v[40:43], v[24:27], 0
  ds_read_b128 v[56:59], v8 offset:18432
  v_mfma_f32_16x16x32_bf16 v[136:139], v[44:47], v[24:27], 0
  ds_read_b128 v[60:63], v8 offset:19456
  s_waitcnt lgkmcnt(12)
  v_mfma_f32_16x16x32_bf16 v[92:95], v[32:35], v[28:31], 0
  v_mfma_f32_16x16x32_bf16 v[108:111], v[36:39], v[28:31], 0
  v_mfma_f32_16x16x32_bf16 v[124:127], v[40:43], v[28:31], 0
  v_mfma_f32_16x16x32_bf16 v[140:143], v[44:47], v[28:31], 0
  s_waitcnt lgkmcnt(9)
  v_mfma_f32_16x16x32_bf16 v[80:83], v[64:67], v[48:51], v[80:83]
  s_add_u32 s34, s34, 1
  s_cmp_eq_u32 s34, 4
  s_cselect_b32 s35, s31, s30
  s_cselect_b32 s34, 0, s34
  v_add_u32 v8, s35, v8
  s_waitcnt lgkmcnt(7)
  v_mfma_f32_16x16x32_bf16 v[96:99], v[68:71], v[48:51], v[96:99]
  v_add_u32_e64 v9, s35, v9
  v_add_u32 v10, s35, v10
  s_waitcnt lgkmcnt(5)
  v_mfma_f32_16x16x32_bf16 v[112:115], v[72:75], v[48:51], v[112:115]
  v_add_u32 v11, s35, v11
  s_waitcnt lgkmcnt(3)
  v_mfma_f32_16x16x32_bf16 v[128:131], v[76:79], v[48:51], v[128:131]
  v_add_u32 v12, s35, v12
  s_waitcnt lgkmcnt(2)
  v_mfma_f32_16x16x32_bf16 v[84:87], v[64:67], v[52:55], v[84:87]
  ds_read_b128 v[16:19], v8 offset:0
  v_mfma_f32_16x16x32_bf16 v[100:103], v[68:71], v[52:55], v[100:103]
  ds_read_b64_tr_b16 v[32:33], v9 offset:0
  v_mfma_f32_16x16x32_bf16 v[116:119], v[72:75], v[52:55], v[116:119]
  ds_read_b64_tr_b16 v[34:35], v9 offset:4096
  v_mfma_f32_16x16x32_bf16 v[132:135], v[76:79], v[52:55], v[132:135]
  ds_read_b64_tr_b16 v[36:37], v10 offset:0
  s_waitcnt lgkmcnt(5)
  v_mfma_f32_16x16x32_bf16 v[88:91], v[64:67], v[56:59], v[88:91]
  ds_read_b64_tr_b16 v[38:39], v10 offset:4096
  v_mfma_f32_16x16x32_bf16 v[104:107], v[68:71], v[56:59], v[104:107]
  ds_read_b64_tr_b16 v[40:41], v11 offset:0
  v_mfma_f32_16x16x32_bf16 v[120:123], v[72:75], v[56:59], v[120:123]
  ds_read_b64_tr_b16 v[42:43], v11 offset:4096
  v_mfma_f32_16x16x32_bf16 v[136:139], v[76:79], v[56:59], v[136:139]
  ds_read_b64_tr_b16 v[44:45], v12 offset:0
  s_waitcnt lgkmcnt(8)
  v_mfma_f32_16x16x32_bf16 v[92:95], v[64:67], v[60:63], v[92:95]
  ds_read_b64_tr_b16 v[46:47], v12 offset:4096
  v_mfma_f32_16x16x32_bf16 v[108:111], v[68:71], v[60:63], v[108:111]
  ds_read_b128 v[20:23], v8 offset:1024
  v_mfma_f32_16x16x32_bf16 v[124:127], v[72:75], v[60:63], v[124:127]
  ds_read_b128 v[24:27], v8 offset:2048
  v_mfma_f32_16x16x32_bf16 v[140:143], v[76:79], v[60:63], v[140:143]
  ds_read_b128 v[28:31], v8 offset:3072
  s_waitcnt lgkmcnt(9)
  v_mfma_f32_16x16x32_bf16 v[80:83], v[32:35], v[16:19], v[80:83]
  ds_read_b128 v[48:51], v8 offset:16384
  s_waitcnt lgkmcnt(8)
  v_mfma_f32_16x16x32_bf16 v[96:99], v[36:39], v[16:19], v[96:99]
  ds_read_b64_tr_b16 v[64:65], v9 offset:16384
  s_waitcnt lgkmcnt(7)
  v_mfma_f32_16x16x32_bf16 v[112:115], v[40:43], v[16:19], v[112:115]
  ds_read_b64_tr_b16 v[66:67], v9 offset:20480
  s_waitcnt lgkmcnt(6)
  v_mfma_f32_16x16x32_bf16 v[128:131], v[44:47], v[16:19], v[128:131]
  ds_read_b64_tr_b16 v[68:69], v10 offset:16384
  s_waitcnt lgkmcnt(6)
  v_mfma_f32_16x16x32_bf16 v[84:87], v[32:35], v[20:23], v[84:87]
  ds_read_b64_tr_b16 v[70:71], v10 offset:20480
  v_mfma_f32_16x16x32_bf16 v[100:103], v[36:39], v[20:23], v[100:103]
  ds_read_b64_tr_b16 v[72:73], v11 offset:16384
  v_mfma_f32_16x16x32_bf16 v[116:119], v[40:43], v[20:23], v[116:119]
  ds_read_b64_tr_b16 v[74:75], v11 offset:20480
  v_mfma_f32_16x16x32_bf16 v[132:135], v[44:47], v[20:23], v[132:135]
  ds_read_b64_tr_b16 v[76:77], v12 offset:16384
  s_waitcnt lgkmcnt(9)
  v_mfma_f32_16x16x32_bf16 v[88:91], v[32:35], v[24:27], v[88:91]
  ds_read_b64_tr_b16 v[78:79], v12 offset:20480
  v_mfma_f32_16x16x32_bf16 v[104:107], v[36:39], v[24:27], v[104:107]
  ds_read_b128 v[52:55], v8 offset:17408
  v_mfma_f32_16x16x32_bf16 v[120:123], v[40:43], v[24:27], v[120:123]
  ds_read_b128 v[56:59], v8 offset:18432
  v_mfma_f32_16x16x32_bf16 v[136:139], v[44:47], v[24:27], v[136:139]
  ds_read_b128 v[60:63], v8 offset:19456
  s_waitcnt lgkmcnt(12)
  v_mfma_f32_16x16x32_bf16 v[92:95], v[32:35], v[28:31], v[92:95]
  v_mfma_f32_16x16x32_bf16 v[108:111], v[36:39], v[28:31], v[108:111]
  v_mfma_f32_16x16x32_bf16 v[124:127], v[40:43], v[28:31], v[124:127]
  v_mfma_f32_16x16x32_bf16 v[140:143], v[44:47], v[28:31], v[140:143]
  s_waitcnt lgkmcnt(9)
  v_mfma_f32_16x16x32_bf16 v[80:83], v[64:67], v[48:51], v[80:83]
  s_add_u32 s34, s34, 1
  s_cmp_eq_u32 s34, 4
  s_cselect_b32 s35, s31, s30
  s_cselect_b32 s34, 0, s34
  v_add_u32 v8, s35, v8
  s_waitcnt lgkmcnt(7)
  v_mfma_f32_16x16x32_bf16 v[96:99], v[68:71], v[48:51], v[96:99]
  v_add_u32_e64 v9, s35, v9
  v_add_u32 v10, s35, v10
  s_waitcnt lgkmcnt(5)
  v_mfma_f32_16x16x32_bf16 v[112:115], v[72:75], v[48:51], v[112:115]
  v_add_u32 v11, s35, v11
  s_waitcnt lgkmcnt(3)
  v_mfma_f32_16x16x32_bf16 v[128:131], v[76:79], v[48:51], v[128:131]
  v_add_u32_e64 v12, s35, v12
  s_waitcnt lgkmcnt(0)
  s_barrier
  v_mfma_f32_16x16x32_bf16 v[84:87], v[64:67], v[52:55], v[84:87]
  ds_read_b128 v[16:19], v8 offset:0
  v_mfma_f32_16x16x32_bf16 v[100:103], v[68:71], v[52:55], v[100:103]
  ds_read_b64_tr_b16 v[32:33], v9 offset:0
  v_mfma_f32_16x16x32_bf16 v[116:119], v[72:75], v[52:55], v[116:119]
  ds_read_b64_tr_b16 v[34:35], v9 offset:4096
  v_mfma_f32_16x16x32_bf16 v[132:135], v[76:79], v[52:55], v[132:135]
  ds_read_b64_tr_b16 v[36:37], v10 offset:0
  v_mfma_f32_16x16x32_bf16 v[88:91], v[64:67], v[56:59], v[88:91]
  ds_read_b64_tr_b16 v[38:39], v10 offset:4096
  v_mfma_f32_16x16x32_bf16 v[104:107], v[68:71], v[56:59], v[104:107]
  ds_read_b64_tr_b16 v[40:41], v11 offset:0
  v_mfma_f32_16x16x32_bf16 v[120:123], v[72:75], v[56:59], v[120:123]
  ds_read_b64_tr_b16 v[42:43], v11 offset:4096
  v_mfma_f32_16x16x32_bf16 v[136:139], v[76:79], v[56:59], v[136:139]
  ds_read_b64_tr_b16 v[44:45], v12 offset:0
  v_mfma_f32_16x16x32_bf16 v[92:95], v[64:67], v[60:63], v[92:95]
  ds_read_b64_tr_b16 v[46:47], v12 offset:4096
  v_mfma_f32_16x16x32_bf16 v[108:111], v[68:71], v[60:63], v[108:111]
  ds_read_b128 v[20:23], v8 offset:1024
  v_mfma_f32_16x16x32_bf16 v[124:127], v[72:75], v[60:63], v[124:127]
  ds_read_b128 v[24:27], v8 offset:2048
  v_mfma_f32_16x16x32_bf16 v[140:143], v[76:79], v[60:63], v[140:143]
  ds_read_b128 v[28:31], v8 offset:3072
  s_mov_b32 s32, 2
B_CLOOP:
  s_waitcnt lgkmcnt(9)
  v_mfma_f32_16x16x32_bf16 v[80:83], v[32:35], v[16:19], v[80:83]
  ds_read_b128 v[48:51], v8 offset:16384
  s_waitcnt lgkmcnt(8)
  v_mfma_f32_16x16x32_bf16 v[96:99], v[36:39], v[16:19], v[96:99]
  ds_read_b64_tr_b16 v[64:65], v9 offset:16384
  s_waitcnt lgkmcnt(7)
  v_mfma_f32_16x16x32_bf16 v[112:115], v[40:43], v[16:19], v[112:115]
  ds_read_b64_tr_b16 v[66:67], v9 offset:20480
  s_waitcnt lgkmcnt(6)
  v_mfma_f32_16x16x32_bf16 v[128:131], v[44:47], v[16:19], v[128:131]
  ds_read_b64_tr_b16 v[68:69], v10 offset:16384
  s_waitcnt lgkmcnt(6)
  v_mfma_f32_16x16x32_bf16 v[84:87], v[32:35], v[20:23], v[84:87]
  ds_read_b64_tr_b16 v[70:71], v10 offset:20480
  v_mfma_f32_16x16x32_bf16 v[100:103], v[36:39], v[20:23], v[100:103]
  ds_read_b64_tr_b16 v[72:73], v11 offset:16384
  v_mfma_f32_16x16x32_bf16 v[116:119], v[40:43], v[20:23], v[116:119]
  ds_read_b64_tr_b16 v[74:75], v11 offset:20480
  v_mfma_f32_16x16x32_bf16 v[132:135], v[44:47], v[20:23], v[132:135]
  ds_read_b64_tr_b16 v[76:77], v12 offset:16384
  s_waitcnt lgkmcnt(9)
  v_mfma_f32_16x16x32_bf16 v[88:91], v[32:35], v[24:27], v[88:91]
  ds_read_b64_tr_b16 v[78:79], v12 offset:20480
  v_mfma_f32_16x16x32_bf16 v[104:107], v[36:39], v[24:27], v[104:107]
  ds_read_b128 v[52:55], v8 offset:17408
  v_mfma_f32_16x16x32_bf16 v[120:123], v[40:43], v[24:27], v[120:123]
  ds_read_b128 v[56:59], v8 offset:18432
  v_mfma_f32_16x16x32_bf16 v[136:139], v[44:47], v[24:27], v[136:139]
  ds_read_b128 v[60:63], v8 offset:19456
  s_waitcnt lgkmcnt(12)
  v_mfma_f32_16x16x32_bf16 v[92:95], v[32:35], v[28:31], v[92:95]
  v_mfma_f32_16x16x32_bf16 v[108:111], v[36:39], v[28:31], v[108:111]
  v_mfma_f32_16x16x32_bf16 v[124:127], v[40:43], v[28:31], v[124:127]
  v_mfma_f32_16x16x32_bf16 v[140:143], v[44:47], v[28:31], v[140:143]
  s_waitcnt lgkmcnt(9)
  v_mfma_f32_16x16x32_bf16 v[80:83], v[64:67], v[48:51], v[80:83]
  s_add_u32 s34, s34, 1
  s_cmp_eq_u32 s34, 4
  s_cselect_b32 s35, s31, s30
  s_cselect_b32 s34, 0, s34
  v_add_u32 v8, s35, v8
  s_waitcnt lgkmcnt(7)
  v_mfma_f32_16x16x32_bf16 v[96:99], v[68:71], v[48:51], v[96:99]
  v_add_u32 v9, s35, v9
  v_add_u32 v10, s35, v10
  s_waitcnt lgkmcnt(5)
  v_mfma_f32_16x16x32_bf16 v[112:115], v[72:75], v[48:51], v[112:115]
  v_add_u32 v11, s35, v11
  s_waitcnt lgkmcnt(3)
  v_mfma_f32_16x16x32_bf16 v[128:131], v[76:79], v[48:51], v[128:131]
  v_add_u32_e64 v12, s35, v12
  s_waitcnt vmcnt(0) lgkmcnt(0)
  s_barrier
  v_mfma_f32_16x16x32_bf16 v[84:87], v[64:67], v[52:55], v[84:87]
  ds_read_b128 v[16:19], v8 offset:0
  v_mfma_f32_16x16x32_bf16 v[100:103], v[68:71], v[52:55], v[100:103]
  ds_read_b64_tr_b16 v[32:33], v9 offset:0
  v_mfma_f32_16x16x32_bf16 v[116:119], v[72:75], v[52:55], v[116:119]
  ds_read_b64_tr_b16 v[34:35], v9 offset:4096
  v_mfma_f32_16x16x32_bf16 v[132:135], v[76:79], v[52:55], v[132:135]
  ds_read_b64_tr_b16 v[36:37], v10 offset:0
  v_mfma_f32_16x16x32_bf16 v[88:91], v[64:67], v[56:59], v[88:91]
  ds_read_b64_tr_b16 v[38:39], v10 offset:4096
  v_mfma_f32_16x16x32_bf16 v[104:107], v[68:71], v[56:59], v[104:107]
  ds_read_b64_tr_b16 v[40:41], v11 offset:0
  v_mfma_f32_16x16x32_bf16 v[120:123], v[72:75], v[56:59], v[120:123]
  ds_read_b64_tr_b16 v[42:43], v11 offset:4096
  v_mfma_f32_16x16x32_bf16 v[136:139], v[76:79], v[56:59], v[136:139]
  ds_read_b64_tr_b16 v[44:45], v12 offset:0
  v_mfma_f32_16x16x32_bf16 v[92:95], v[64:67], v[60:63], v[92:95]
  ds_read_b64_tr_b16 v[46:47], v12 offset:4096
  v_mfma_f32_16x16x32_bf16 v[108:111], v[68:71], v[60:63], v[108:111]
  ds_read_b128 v[20:23], v8 offset:1024
  v_mfma_f32_16x16x32_bf16 v[124:127], v[72:75], v[60:63], v[124:127]
  ds_read_b128 v[24:27], v8 offset:2048
  v_mfma_f32_16x16x32_bf16 v[140:143], v[76:79], v[60:63], v[140:143]
  ds_read_b128 v[28:31], v8 offset:3072
  s_add_u32 s32, s32, 1
  s_cmp_lt_u32 s32, 27
  s_cbranch_scc1 B_CLOOP
  s_waitcnt lgkmcnt(9)
  v_mfma_f32_16x16x32_bf16 v[80:83], v[32:35], v[16:19], v[80:83]
  ds_read_b128 v[48:51], v8 offset:16384
  s_waitcnt lgkmcnt(8)
  v_mfma_f32_16x16x32_bf16 v[96:99], v[36:39], v[16:19], v[96:99]
  ds_read_b64_tr_b16 v[64:65], v9 offset:16384
  s_waitcnt lgkmcnt(7)
  v_mfma_f32_16x16x32_bf16 v[112:115], v[40:43], v[16:19], v[112:115]
  ds_read_b64_tr_b16 v[66:67], v9 offset:20480
  s_waitcnt lgkmcnt(6)
  v_mfma_f32_16x16x32_bf16 v[128:131], v[44:47], v[16:19], v[128:131]
  ds_read_b64_tr_b16 v[68:69], v10 offset:16384
  s_waitcnt lgkmcnt(6)
  v_mfma_f32_16x16x32_bf16 v[84:87], v[32:35], v[20:23], v[84:87]
  ds_read_b64_tr_b16 v[70:71], v10 offset:20480
  v_mfma_f32_16x16x32_bf16 v[100:103], v[36:39], v[20:23], v[100:103]
  ds_read_b64_tr_b16 v[72:73], v11 offset:16384
  v_mfma_f32_16x16x32_bf16 v[116:119], v[40:43], v[20:23], v[116:119]
  ds_read_b64_tr_b16 v[74:75], v11 offset:20480
  v_mfma_f32_16x16x32_bf16 v[132:135], v[44:47], v[20:23], v[132:135]
  ds_read_b64_tr_b16 v[76:77], v12 offset:16384
  s_waitcnt lgkmcnt(9)
  v_mfma_f32_16x16x32_bf16 v[88:91], v[32:35], v[24:27], v[88:91]
  ds_read_b64_tr_b16 v[78:79], v12 offset:20480
  v_mfma_f32_16x16x32_bf16 v[104:107], v[36:39], v[24:27], v[104:107]
  ds_read_b128 v[52:55], v8 offset:17408
  v_mfma_f32_16x16x32_bf16 v[120:123], v[40:43], v[24:27], v[120:123]
  ds_read_b128 v[56:59], v8 offset:18432
  v_mfma_f32_16x16x32_bf16 v[136:139], v[44:47], v[24:27], v[136:139]
  ds_read_b128 v[60:63], v8 offset:19456
  s_waitcnt lgkmcnt(12)
  v_mfma_f32_16x16x32_bf16 v[92:95], v[32:35], v[28:31], v[92:95]
  v_mfma_f32_16x16x32_bf16 v[108:111], v[36:39], v[28:31], v[108:111]
  v_mfma_f32_16x16x32_bf16 v[124:127], v[40:43], v[28:31], v[124:127]
  v_mfma_f32_16x16x32_bf16 v[140:143], v[44:47], v[28:31], v[140:143]
  s_waitcnt lgkmcnt(5)
  v_mfma_f32_16x16x32_bf16 v[112:115], v[72:75], v[48:51], v[112:115]
  s_waitcnt lgkmcnt(2)
  v_mfma_f32_16x16x32_bf16 v[116:119], v[72:75], v[52:55], v[116:119]
  s_waitcnt lgkmcnt(1)
  v_mfma_f32_16x16x32_bf16 v[120:123], v[72:75], v[56:59], v[120:123]
  s_waitcnt lgkmcnt(0)
  v_mfma_f32_16x16x32_bf16 v[124:127], v[72:75], v[60:63], v[124:127]
  s_mov_b32 s40, s66
  s_and_b32 s41, s67, 0xffff
  s_mov_b32 s42, 0x400000
  s_mov_b32 s43, 0x00020000
  s_lshl_b32 s21, s2, 14
  v_mfma_f32_16x16x32_bf16 v[128:131], v[76:79], v[48:51], v[128:131]
  s_lshl_b32 s22, s16, 12
  s_add_u32 s21, s21, s22
  s_add_u32 s21, s21, 0x2200000
  v_lshlrev_b32 v8, 4, v1
  v_add_u32 v9, s21, v8
  v_mfma_f32_16x16x32_bf16 v[132:135], v[76:79], v[52:55], v[132:135]
  s_xor_b32 s21, s21, 0x10000
  v_add_u32 v10, s21, v8
  s_lshl_b32 s21, s18, 13
  s_add_u32 s21, s21, 131072
  s_lshl_b32 s23, s17, 7
  v_mfma_f32_16x16x32_bf16 v[136:139], v[76:79], v[56:59], v[136:139]
  v_xor_b32 v14, s23, v14
  v_add_u32 v14, s21, v14
  v_xor_b32 v15, 32, v14
  v_xor_b32_e64 v12, 64, v14
  v_xor_b32 v13, 96, v14
  v_mfma_f32_16x16x32_bf16 v[140:143], v[76:79], v[60:63], v[140:143]
  v_cvt_pk_bf16_f32 v32, v112, v113
  v_cvt_pk_bf16_f32 v33, v114, v115
  v_cvt_pk_bf16_f32 v34, v116, v117
  v_cvt_pk_bf16_f32 v35, v118, v119
  v_or_b32_e64 v32, 1, v32
  v_mfma_f32_16x16x32_bf16 v[80:83], v[64:67], v[48:51], v[80:83]
  v_or_b32 v33, 1, v33
  v_or_b32 v34, 1, v34
  v_or_b32_e64 v35, 1, v35
  buffer_store_dwordx4 v[32:35], v9, s[44:47], 0 offen offset:0 sc1
  v_cvt_pk_bf16_f32 v36, v120, v121
  v_mfma_f32_16x16x32_bf16 v[84:87], v[64:67], v[52:55], v[84:87]
  v_cvt_pk_bf16_f32 v37, v122, v123
  v_cvt_pk_bf16_f32 v38, v124, v125
  v_cvt_pk_bf16_f32 v39, v126, v127
  v_or_b32 v36, 1, v36
  v_or_b32 v37, 1, v37
  v_mfma_f32_16x16x32_bf16 v[88:91], v[64:67], v[56:59], v[88:91]
  v_or_b32 v38, 1, v38
  v_or_b32 v39, 1, v39
  buffer_store_dwordx4 v[36:39], v9, s[44:47], 0 offen offset:1024 sc1
  v_cvt_pk_bf16_f32 v40, v128, v129
  v_cvt_pk_bf16_f32 v41, v130, v131
  v_mfma_f32_16x16x32_bf16 v[92:95], v[64:67], v[60:63], v[92:95]
  v_cvt_pk_bf16_f32 v42, v132, v133
  v_cvt_pk_bf16_f32 v43, v134, v135
  v_or_b32 v40, 1, v40
  v_or_b32 v41, 1, v41
  v_or_b32_e64 v42, 1, v42
  v_mfma_f32_16x16x32_bf16 v[96:99], v[68:71], v[48:51], v[96:99]
  v_or_b32_e64 v43, 1, v43
  buffer_store_dwordx4 v[40:43], v9, s[44:47], 0 offen offset:2048 sc1
  v_cvt_pk_bf16_f32 v44, v136, v137
  v_cvt_pk_bf16_f32 v45, v138, v139
  v_cvt_pk_bf16_f32 v46, v140, v141
  v_mfma_f32_16x16x32_bf16 v[100:103], v[68:71], v[52:55], v[100:103]
  v_cvt_pk_bf16_f32 v47, v142, v143
  v_or_b32 v44, 1, v44
  v_or_b32 v45, 1, v45
  v_or_b32 v46, 1, v46
  v_or_b32 v47, 1, v47
  v_mfma_f32_16x16x32_bf16 v[104:107], v[68:71], v[56:59], v[104:107]
  buffer_store_dwordx4 v[44:47], v9, s[44:47], 0 offen offset:3072 sc1
  ds_read_b64_tr_b16 v[16:17], v14 offset:0
  ds_read_b64_tr_b16 v[18:19], v15 offset:0
  ds_read_b64_tr_b16 v[20:21], v12 offset:0
  ds_read_b64_tr_b16 v[22:23], v13 offset:0
  v_mfma_f32_16x16x32_bf16 v[108:111], v[68:71], v[60:63], v[108:111]
  ds_read_b64_tr_b16 v[24:25], v14 offset:4096
  ds_read_b64_tr_b16 v[26:27], v15 offset:4096
  ds_read_b64_tr_b16 v[28:29], v12 offset:4096
  ds_read_b64_tr_b16 v[30:31], v13 offset:4096
  v_and_b32 v11, 15, v1
  v_lshlrev_b32 v11, 11, v11
  v_lshlrev_b32 v6, 5, v5
  v_lshrrev_b32 v7, 1, v2
  v_lshlrev_b32_e64 v7, 4, v7
  v_add3_u32 v11, v11, v6, v7
  s_lshl_b32 s21, s14, 18
  s_lshl_b32 s23, s17, 17
  s_add_u32 s21, s21, s23
  s_lshl_b32 s23, s15, 8
  s_add_u32 s21, s21, s23
  s_lshl_b32 s23, s19, 7
  s_add_u32 s21, s21, s23
  s_lshl_b32 s23, s18, 6
  s_add_u32 s21, s21, s23
  v_add_u32 v11, s21, v11
  s_mov_b32 s33, 0xffff0000
  s_mov_b32 s24, 32768
  s_mov_b32 s25, 65536
  s_mov_b32 s26, 98304
  s_mov_b32 s23, 0
  s_waitcnt lgkmcnt(0)
  v_lshlrev_b32 v112, 16, v16
  v_and_b32 v113, s33, v16
  v_lshlrev_b32 v114, 16, v17
  v_and_b32 v115, s33, v17
  v_lshlrev_b32 v116, 16, v18
  v_and_b32 v117, s33, v18
  v_lshlrev_b32 v118, 16, v19
  v_and_b32 v119, s33, v19
  v_lshlrev_b32 v120, 16, v20
  v_and_b32 v121, s33, v20
  v_lshlrev_b32 v122, 16, v21
  v_and_b32 v123, s33, v21
  v_lshlrev_b32 v124, 16, v22
  v_and_b32 v125, s33, v22
  v_lshlrev_b32 v126, 16, v23
  v_and_b32 v127, s33, v23
  v_lshlrev_b32 v128, 16, v24
  v_and_b32 v129, s33, v24
  v_lshlrev_b32 v130, 16, v25
  v_and_b32 v131, s33, v25
  v_lshlrev_b32 v132, 16, v26
  v_and_b32 v133, s33, v26
  v_lshlrev_b32 v134, 16, v27
  v_and_b32 v135, s33, v27
  v_lshlrev_b32 v136, 16, v28
  v_and_b32 v137, s33, v28
  v_lshlrev_b32 v138, 16, v29
  v_and_b32 v139, s33, v29
  v_lshlrev_b32 v140, 16, v30
  v_and_b32 v141, s33, v30
  v_lshlrev_b32 v142, 16, v31
  v_and_b32 v143, s33, v31
B_GET:
  buffer_load_dwordx4 v[48:51], v10, s[44:47], 0 offen offset:0 sc0 sc1
  buffer_load_dwordx4 v[52:55], v10, s[44:47], 0 offen offset:1024 sc0 sc1
  buffer_load_dwordx4 v[56:59], v10, s[44:47], 0 offen offset:2048 sc0 sc1
  buffer_load_dwordx4 v[60:63], v10, s[44:47], 0 offen offset:3072 sc0 sc1
  s_waitcnt vmcnt(0)
  v_and_b32 v64, v48, v49
  v_bitop3_b32 v64, v64, v50, v51 bitop3:0x80
  v_bitop3_b32 v64, v64, v52, v53 bitop3:0x80
  v_bitop3_b32 v64, v64, v54, v55 bitop3:0x80
  v_bitop3_b32 v64, v64, v56, v57 bitop3:0x80
  v_bitop3_b32 v64, v64, v58, v59 bitop3:0x80
  v_bitop3_b32 v64, v64, v60, v61 bitop3:0x80
  v_bitop3_b32 v64, v64, v62, v63 bitop3:0x80
  v_and_b32_e64 v64, 1, v64
  v_cmp_eq_u32 vcc, 0, v64
  s_add_u32 s23, s23, 1
  s_cmp_ge_u32 s23, 0x200000
  s_cbranch_scc1 B_ALL
  s_cmp_eq_u64 vcc, 0
  s_cbranch_scc0 B_GET
B_ALL:
  v_lshlrev_b32 v16, 16, v48
  v_and_b32 v17, s33, v48
  v_lshlrev_b32 v18, 16, v49
  v_and_b32_e64 v19, s33, v49
  v_pk_add_f32 v[80:81], v[80:81], v[16:17]
  v_pk_add_f32 v[82:83], v[82:83], v[18:19]
  v_cvt_pk_bf16_f32 v80, v80, v81
  v_cvt_pk_bf16_f32 v82, v82, v83
  v_and_b32 v81, s33, v80
  v_lshlrev_b32 v80, 16, v80
  v_and_b32 v83, s33, v82
  v_lshlrev_b32 v82, 16, v82
  v_pk_add_f32 v[80:81], v[80:81], v[112:113]
  v_pk_add_f32 v[82:83], v[82:83], v[114:115]
  v_cvt_pk_bf16_f32 v144, v80, v81
  v_cvt_pk_bf16_f32 v145, v82, v83
  v_lshlrev_b32 v20, 16, v56
  v_and_b32 v21, s33, v56
  v_lshlrev_b32 v22, 16, v57
  v_and_b32 v23, s33, v57
  v_pk_add_f32 v[96:97], v[96:97], v[20:21]
  v_pk_add_f32 v[98:99], v[98:99], v[22:23]
  v_cvt_pk_bf16_f32 v96, v96, v97
  v_cvt_pk_bf16_f32 v98, v98, v99
  v_and_b32 v97, s33, v96
  v_lshlrev_b32 v96, 16, v96
  v_and_b32 v99, s33, v98
  v_lshlrev_b32 v98, 16, v98
  v_pk_add_f32 v[96:97], v[96:97], v[128:129]
  v_pk_add_f32 v[98:99], v[98:99], v[130:131]
  v_cvt_pk_bf16_f32 v146, v96, v97
  v_cvt_pk_bf16_f32 v147, v98, v99
  s_nop 1
  v_permlane16_swap_b32 v144, v146
  v_permlane16_swap_b32 v145, v147
  buffer_store_dwordx4 v[144:147], v11, s[40:43], 0 offen sc1
  v_lshlrev_b32 v16, 16, v50
  v_and_b32 v17, s33, v50
  v_lshlrev_b32 v18, 16, v51
  v_and_b32_e64 v19, s33, v51
  v_pk_add_f32 v[84:85], v[84:85], v[16:17]
  v_pk_add_f32 v[86:87], v[86:87], v[18:19]
  v_cvt_pk_bf16_f32 v84, v84, v85
  v_cvt_pk_bf16_f32 v86, v86, v87
  v_and_b32 v85, s33, v84
  v_lshlrev_b32 v84, 16, v84
  v_and_b32 v87, s33, v86
  v_lshlrev_b32 v86, 16, v86
  v_pk_add_f32 v[84:85], v[84:85], v[116:117]
  v_pk_add_f32 v[86:87], v[86:87], v[118:119]
  v_cvt_pk_bf16_f32 v148, v84, v85
  v_cvt_pk_bf16_f32 v149, v86, v87
  v_lshlrev_b32 v20, 16, v58
  v_and_b32 v21, s33, v58
  v_lshlrev_b32 v22, 16, v59
  v_and_b32 v23, s33, v59
  v_pk_add_f32 v[100:101], v[100:101], v[20:21]
  v_pk_add_f32 v[102:103], v[102:103], v[22:23]
  v_cvt_pk_bf16_f32 v100, v100, v101
  v_cvt_pk_bf16_f32 v102, v102, v103
  v_and_b32 v101, s33, v100
  v_lshlrev_b32 v100, 16, v100
  v_and_b32 v103, s33, v102
  v_lshlrev_b32 v102, 16, v102
  v_pk_add_f32 v[100:101], v[100:101], v[132:133]
  v_pk_add_f32 v[102:103], v[102:103], v[134:135]
  v_cvt_pk_bf16_f32 v150, v100, v101
  v_cvt_pk_bf16_f32 v151, v102, v103
  s_nop 1
  v_permlane16_swap_b32 v148, v150
  v_permlane16_swap_b32 v149, v151
  buffer_store_dwordx4 v[148:151], v11, s[40:43], s24 offen sc1
  v_lshlrev_b32 v16, 16, v52
  v_and_b32 v17, s33, v52
  v_lshlrev_b32 v18, 16, v53
  v_and_b32_e64 v19, s33, v53
  v_pk_add_f32 v[88:89], v[88:89], v[16:17]
  v_pk_add_f32 v[90:91], v[90:91], v[18:19]
  v_cvt_pk_bf16_f32 v88, v88, v89
  v_cvt_pk_bf16_f32 v90, v90, v91
  v_and_b32 v89, s33, v88
  v_lshlrev_b32 v88, 16, v88
  v_and_b32 v91, s33, v90
  v_lshlrev_b32 v90, 16, v90
  v_pk_add_f32 v[88:89], v[88:89], v[120:121]
  v_pk_add_f32 v[90:91], v[90:91], v[122:123]
  v_cvt_pk_bf16_f32 v152, v88, v89
  v_cvt_pk_bf16_f32 v153, v90, v91
  v_lshlrev_b32 v20, 16, v60
  v_and_b32 v21, s33, v60
  v_lshlrev_b32 v22, 16, v61
  v_and_b32 v23, s33, v61
  v_pk_add_f32 v[104:105], v[104:105], v[20:21]
  v_pk_add_f32 v[106:107], v[106:107], v[22:23]
  v_cvt_pk_bf16_f32 v104, v104, v105
  v_cvt_pk_bf16_f32 v106, v106, v107
  v_and_b32 v105, s33, v104
  v_lshlrev_b32 v104, 16, v104
  v_and_b32 v107, s33, v106
  v_lshlrev_b32 v106, 16, v106
  v_pk_add_f32 v[104:105], v[104:105], v[136:137]
  v_pk_add_f32 v[106:107], v[106:107], v[138:139]
  v_cvt_pk_bf16_f32 v154, v104, v105
  v_cvt_pk_bf16_f32 v155, v106, v107
  s_nop 1
  v_permlane16_swap_b32 v152, v154
  v_permlane16_swap_b32 v153, v155
  buffer_store_dwordx4 v[152:155], v11, s[40:43], s25 offen sc1
  v_lshlrev_b32 v16, 16, v54
  v_and_b32 v17, s33, v54
  v_lshlrev_b32 v18, 16, v55
  v_and_b32_e64 v19, s33, v55
  v_pk_add_f32 v[92:93], v[92:93], v[16:17]
  v_pk_add_f32 v[94:95], v[94:95], v[18:19]
  v_cvt_pk_bf16_f32 v92, v92, v93
  v_cvt_pk_bf16_f32 v94, v94, v95
  v_and_b32 v93, s33, v92
  v_lshlrev_b32 v92, 16, v92
  v_and_b32 v95, s33, v94
  v_lshlrev_b32 v94, 16, v94
  v_pk_add_f32 v[92:93], v[92:93], v[124:125]
  v_pk_add_f32 v[94:95], v[94:95], v[126:127]
  v_cvt_pk_bf16_f32 v156, v92, v93
  v_cvt_pk_bf16_f32 v157, v94, v95
  v_lshlrev_b32 v20, 16, v62
  v_and_b32 v21, s33, v62
  v_lshlrev_b32 v22, 16, v63
  v_and_b32 v23, s33, v63
  v_pk_add_f32 v[108:109], v[108:109], v[20:21]
  v_pk_add_f32 v[110:111], v[110:111], v[22:23]
  v_cvt_pk_bf16_f32 v108, v108, v109
  v_cvt_pk_bf16_f32 v110, v110, v111
  v_and_b32 v109, s33, v108
  v_lshlrev_b32 v108, 16, v108
  v_and_b32 v111, s33, v110
  v_lshlrev_b32 v110, 16, v110
  v_pk_add_f32 v[108:109], v[108:109], v[140:141]
  v_pk_add_f32 v[110:111], v[110:111], v[142:143]
  v_cvt_pk_bf16_f32 v158, v108, v109
  v_cvt_pk_bf16_f32 v159, v110, v111
  s_nop 1
  v_permlane16_swap_b32 v156, v158
  v_permlane16_swap_b32 v157, v159
  buffer_store_dwordx4 v[156:159], v11, s[40:43], s26 offen sc1
  s_endpgm

MK_END:
  s_endpgm
.section .rodata,"a"
.p2align 6
.amdhsa_kernel sequential_preLN__ssm_conv_h3__dense_activation_silu__prompt_kernel
  .amdhsa_next_free_vgpr 232
  .amdhsa_next_free_sgpr 102
  .amdhsa_accum_offset 232
  .amdhsa_group_segment_fixed_size 0
  .amdhsa_kernarg_size 96
  .amdhsa_user_sgpr_count 2
  .amdhsa_user_sgpr_kernarg_segment_ptr 1
  .amdhsa_system_sgpr_workgroup_id_x 1
.end_amdhsa_kernel
```
